```python
import torch

def _softmax(x, axis=-1):
    return torch.softmax(x, dim=axis)

def _gelu(x):
    return torch.nn.functional.gelu(x, approximate='tanh')

def _silu(x):
    return torch.nn.functional.silu(x)

def _sigmoid(x):
    return torch.sigmoid(x)

def _layernorm(x, axis=-1, eps=1e-05):
    m = x.mean(dim=axis, keepdim=True)
    v = x.var(dim=axis, keepdim=True, unbiased=False)
    return (x - m) / torch.sqrt(v + eps)

def _scatter_add(tgt, idx, src, axis=0):
    return tgt.clone().index_add_(axis, idx, src)

def _segment_sum(src, seg, n):
    out = torch.zeros((n,) + src.shape[1:], dtype=src.dtype)
    return out.index_add_(0, seg, src)

def _pad(x, pw):
    flat = tuple((v for pair in reversed(pw) for v in pair))
    return torch.nn.functional.pad(x, flat)
kernel_name = 'adaLN_cond__sliding_block_cached__glu_gated_reglu__decode'

def setup_inputs():

    _w = lambda a: (lambda t: t.to(torch.bfloat16) if t.is_floating_point() else t)(torch.as_tensor(a))

    def _A_setup():
        B, Sq, D = (2, 1, 512)
        Hq, Hkv, Sk, Dh = (32, 8, 8192, 128)
        assert Hq % Hkv == 0, (Hq, Hkv)
        return {'x': _w((lambda *s: torch.randn(*s, dtype=torch.bfloat16) * 0.1)(B, Sq, D)), 'k_cache': _w((lambda *s: torch.randn(*s, dtype=torch.bfloat16) * 0.8)(B, Hkv, Sk, Dh)), 'v_cache': _w((lambda *s: torch.randn(*s, dtype=torch.bfloat16) * 3.2)(B, Hkv, Sk, Dh)), 'wq': _w((lambda *s: torch.randn(*s, dtype=torch.bfloat16) * 0.8)(D, Hq * Dh) * D ** (-0.5)), 'wo': _w((lambda *s: torch.randn(*s, dtype=torch.bfloat16) * 3.2)(Hq * Dh, D) * (Hq * Dh) ** (-0.5))}
    _A_in = _A_setup()

    def _B_setup():
        B, S, D, F = (2, 1, 512, 1792)
        return {'x': _w((lambda *s: torch.randn(*s, dtype=torch.bfloat16) * 0.1)(B, S, D)), 'W_gate': _w((lambda *s: torch.randn(*s, dtype=torch.bfloat16) * 3.2)(D, F) * (2.0 / D) ** 0.5), 'W_up': _w((lambda *s: torch.randn(*s, dtype=torch.bfloat16) * 3.2)(D, F) * (2.0 / D) ** 0.5), 'W_down': _w((lambda *s: torch.randn(*s, dtype=torch.bfloat16) * 3.2)(F, D) * (1.0 / F) ** 0.5)}
    _B_in = _B_setup()
    return {'A_x': _A_in['x'], 'A_k_cache': _A_in['k_cache'], 'A_v_cache': _A_in['v_cache'], 'A_wq': _A_in['wq'], 'A_wo': _A_in['wo'], 'B_x': _B_in['x'], 'B_W_gate': _B_in['W_gate'], 'B_W_up': _B_in['W_up'], 'B_W_down': _B_in['W_down'], 'c': _w((lambda *s: torch.randn(*s, dtype=torch.bfloat16) * 0.1)(2, 512) * 8.0), 'w_mod': _w((lambda *s: torch.randn(*s, dtype=torch.bfloat16) * 0.1)(512, 6 * 512) * 512 ** (-0.5) * 8.0)}

def reference(A_x, A_k_cache, A_v_cache, A_wq, A_wo, B_x, B_W_gate, B_W_up, B_W_down, c, w_mod):

    def _A_ref(x, k_cache, v_cache, wq, wo):
        B, Sq, D = x.shape
        Hq, Dh = (32, 128)
        Hkv, Sk = (k_cache.shape[1], k_cache.shape[2])
        W = min(4096, max(256, Sk // 4))
        rep = Hq // Hkv
        q = (lambda x, *d: x.permute(*d))((x @ wq).reshape(B, Sq, Hq, Dh), 0, 2, 1, 3)
        k = (lambda x, n, axis: torch.repeat_interleave(x, n, dim=axis))(k_cache[:, :, Sk - W:, :], rep, axis=1)
        v = (lambda x, n, axis: torch.repeat_interleave(x, n, dim=axis))(v_cache[:, :, Sk - W:, :], rep, axis=1)
        scores = torch.einsum('bhqd,bhkd->bhqk', q, k) * Dh ** (-0.5)
        p = _softmax(scores, axis=-1)
        o = torch.einsum('bhqk,bhkd->bhqd', p, v)
        return (lambda x, *d: x.permute(*d))(o, 0, 2, 1, 3).reshape(B, Sq, Hq * Dh) @ wo

    def _B_ref(x, W_gate, W_up, W_down):
        gate = torch.einsum('bsd,df->bsf', x, W_gate)
        up = torch.einsum('bsd,df->bsf', x, W_up)
        gate = gate * (lambda x, dt: x.to(dt))(gate > 0, gate.dtype)
        h = gate * up
        return torch.einsum('bsf,fd->bsd', h, W_down)
    x = A_x
    mod = (_silu(c) @ w_mod).reshape(c.shape[0], 6, 1, -1)
    sa, ca, ga, sb, cb, gb = (mod[:, 0].clone(), mod[:, 1].clone(), mod[:, 2].clone(), mod[:, 3].clone(), mod[:, 4].clone(), mod[:, 5].clone())
    h = _layernorm(x, axis=-1) * (1 + ca) + sa
    x = x + ga * _A_ref(h, A_k_cache, A_v_cache, A_wq, A_wo)
    h = _layernorm(x, axis=-1) * (1 + cb) + sb
    x = x + gb * _B_ref(h, B_W_gate, B_W_up, B_W_down)
    return x
```

```asm
; @launch grid=(256,1,1) block=(512,1,1) lds=152832
.amdgcn_target "amdgcn-amd-amdhsa--gfx950"
.text
.globl adaLN_cond__sliding_block_cached__glu_gated_reglu__decode_kernel
.p2align 8
.type adaLN_cond__sliding_block_cached__glu_gated_reglu__decode_kernel,@function
adaLN_cond__sliding_block_cached__glu_gated_reglu__decode_kernel:
    s_cmp_ge_u32 s2, 256
    s_cbranch_scc1 L_end
    s_cmp_ge_u32 s2, 128
    s_cselect_b32 s40, 24, 8
    s_cselect_b32 s41, 0, 16
    s_load_dwordx2 s[8:9], s[0:1], s40
    s_load_dwordx2 s[20:21], s[0:1], 80
    s_load_dwordx2 s[24:25], s[0:1], s41
    s_load_dwordx2 s[28:29], s[0:1], 72
    s_load_dwordx2 s[16:17], s[0:1], 104
    v_readfirstlane_b32 s3, v0
    s_cbranch_scc1 L_npf_1
    s_getpc_b64 s[38:39]
    v_and_b32 v11, 0x1c0, v0
    s_lshl_b32 s40, s2, 7
    s_and_b32 s38, s38, 0xffffff00
    s_and_b32 s40, s40, 0x3c00
    v_lshl_or_b32 v11, v11, 1, s40
    global_load_dword v11, v11, s[38:39]
L_npf_1:
    v_and_b32 v0, 63, v0
    s_mov_b32 s11, 0x00020000
    v_lshrrev_b32 v1, 4, v0
    v_and_b32 v2, 15, v0
    s_add_u32 s4, s2, 7
    s_and_b32 s4, s4, 7
    s_bfe_u32 s6, s2, 0x10006
    s_bfe_u32 s7, s2, 0x30003
    v_lshlrev_b32 v10, 1, v1
    v_xor_b32 v10, v2, v10
    v_lshlrev_b32 v10, 4, v10
    s_mov_b32 s27, s11
    v_and_b32 v8, 0x70, v10
    v_lshrrev_b32 v7, 3, v0
    s_cmp_lt_u32 s2, 128
    s_cbranch_scc1 L_KV
    s_mov_b32 s22, 3145728
    s_mov_b32 s23, s11
    v_mul_u32_u24 v3, 6144, v7
    s_lshl_b32 s46, s7, 7
    v_add_u32 v3, v3, v8
    s_cmp_lg_u32 s6, 0
    s_cbranch_scc1 L_nA
    s_lshl_b32 s49, s4, 7
    s_cmp_lt_u32 s3, 256
    s_cbranch_scc1 L_A1
    s_sub_u32 s40, s3, 256
    s_lshl_b32 s61, s7, 6
    s_lshr_b32 s45, s40, 2
    s_add_u32 s61, s61, s45
    s_mul_i32 s61, s61, 6144
    s_add_u32 s61, s61, s49
    s_add_u32 s62, s61, 48128
    s_lshl_b32 s40, s40, 5
    s_add_u32 m0, s40, 131072
    s_waitcnt lgkmcnt(0)
    buffer_load_dwordx4 v3, s[20:23], s61 offen nt lds
    buffer_load_dwordx4 v3, s[20:23], s62 offen offset:1024 nt lds
    s_add_u32 m0, s40, 138240
    s_nop 0
    buffer_load_dwordx4 v3, s[20:23], s61 offen offset:1024 nt lds
    buffer_load_dwordx4 v3, s[20:23], s62 offen offset:2048 nt lds
    v_lshl_or_b32 v4, v7, 13, v8
    s_mov_b32 s10, 4194304
    s_lshl_b32 s48, s3, 6
    s_lshl_b32 s43, s6, 8
    s_lshr_b32 s45, s48, 7
    s_add_u32 s43, s43, s45
    s_lshl_b32 s44, s43, 13
    s_lshl_b32 s45, s4, 10
    s_add_u32 s44, s44, s45
    s_add_u32 s44, s44, s46
    s_barrier
    s_add_u32 m0, s48, 0
    s_nop 0
    buffer_load_dwordx4 v4, s[8:11], s44 offen offset:0 nt lds
    s_add_u32 s44, s44, 64512
    buffer_load_dwordx4 v4, s[8:11], s44 offen offset:1024 nt lds
    s_add_u32 s44, s44, 64512
    buffer_load_dwordx4 v4, s[8:11], s44 offen offset:2048 nt lds
    s_add_u32 s44, s44, 64512
    buffer_load_dwordx4 v4, s[8:11], s44 offen offset:3072 nt lds
    s_waitcnt vmcnt(4)
    s_barrier
    s_branch L_c_37
L_A1:
    v_lshrrev_b32 v9, 5, v0
    v_lshlrev_b32 v9, 10, v9
    v_and_b32 v10, 31, v0
    v_lshl_or_b32 v9, v10, 2, v9
    s_movk_i32 s30, 2048
    s_mov_b32 s31, s11
    v_bfe_u32 v36, v0, 4, 1
    v_lshlrev_b32 v36, 10, v36
    v_lshrrev_b32 v10, 5, v0
    v_lshl_or_b32 v36, v10, 8, v36
    v_lshl_or_b32 v36, v2, 4, v36
    s_movk_i32 s26, 2048
    s_waitcnt lgkmcnt(0)
    buffer_load_dword v12, v9, s[28:31], s46 offen
    buffer_load_dwordx4 v[16:19], v36, s[24:27], 0 offen
    buffer_load_dwordx4 v[20:23], v36, s[24:27], 0 offen offset:512
    v_bfe_u32 v37, v0, 4, 1
    v_lshlrev_b32 v37, 10, v37
    v_lshl_or_b32 v37, v2, 1, v37
    s_lshr_b32 s50, s3, 1
    s_add_u32 s50, s50, s49
    v_mov_b32 v13, 0
    buffer_load_short_d16_hi v13, v37, s[24:27], s50 offen
    s_load_dword s36, s[16:17], 0
    s_barrier
    s_branch L_c_38
L_nA:
    v_lshl_or_b32 v4, v7, 13, v8
    s_mov_b32 s10, 4194304
    s_lshl_b32 s48, s3, 6
    s_lshl_b32 s43, s6, 8
    s_lshr_b32 s45, s48, 7
    s_add_u32 s43, s43, s45
    s_lshl_b32 s44, s43, 13
    s_lshl_b32 s45, s4, 10
    s_add_u32 s44, s44, s45
    s_add_u32 s44, s44, s46
    s_lshl_b32 s51, s7, 6
    s_lshr_b32 s45, s3, 3
    s_add_u32 s51, s51, s45
    s_lshl_b32 s52, s51, 13
    s_lshl_b32 s45, s4, 10
    s_add_u32 s52, s52, s45
    s_add_u32 s52, s52, 0x180
    s_mul_i32 s51, s51, 6144
    s_waitcnt lgkmcnt(0)
    s_cmp_lg_u32 s4, 3
    s_cbranch_scc1 L_n3a_39
    buffer_load_dword v11, v3, s[20:23], s51 offen offset:1408
L_n3a_39:
    buffer_load_dword v11, v4, s[8:11], s52 offen
    s_add_u32 m0, s48, 0
    s_nop 0
    buffer_load_dwordx4 v4, s[8:11], s44 offen offset:0 nt lds
    s_add_u32 s44, s44, 64512
    buffer_load_dwordx4 v4, s[8:11], s44 offen offset:1024 nt lds
    s_add_u32 s44, s44, 64512
    buffer_load_dwordx4 v4, s[8:11], s44 offen offset:2048 nt lds
    s_add_u32 s44, s44, 64512
    buffer_load_dwordx4 v4, s[8:11], s44 offen offset:3072 nt lds
    s_lshl_b32 s42, s3, 4
    s_lshl_b32 s40, s4, 8
    s_add_u32 s40, s40, 0x800
    s_add_u32 s51, s51, s40
    v_lshrrev_b32 v9, 5, v0
    v_lshlrev_b32 v9, 10, v9
    v_and_b32 v10, 31, v0
    v_lshl_or_b32 v9, v10, 2, v9
    s_movk_i32 s30, 2048
    s_mov_b32 s31, s11
    buffer_load_dword v12, v9, s[28:31], s46 offen
    s_barrier
    s_add_u32 m0, s42, 65536
    s_nop 0
    buffer_load_dwordx4 v3, s[20:23], s51 offen offset:0 nt lds
    s_add_u32 m0, s42, 73600
    s_nop 0
    buffer_load_dwordx4 v3, s[20:23], s51 offen offset:128 nt lds
    s_add_u32 m0, s42, 79872
    s_nop 0
    buffer_load_dwordx4 v3, s[20:23], s51 offen offset:2048 nt lds
    s_add_u32 m0, s42, 87936
    s_nop 0
    buffer_load_dwordx4 v3, s[20:23], s51 offen offset:2176 nt lds
    s_branch L_wc
L_KV:
    v_lshl_or_b32 v120, v1, 8, v10
    v_xor_b32 v121, 0x80, v120
    s_lshl_b32 s43, s3, 7
    s_mov_b32 s10, 33554432
    s_mov_b32 s26, s10
    s_lshl_b32 s56, s6, 24
    s_lshl_b32 s45, s4, 21
    s_add_u32 s56, s56, s45
    s_lshl_b32 s45, s7, 16
    s_add_u32 s56, s56, s45
    s_lshr_b32 s45, s3, 7
    s_lshl_b32 s45, s45, 14
    s_add_u32 s56, s56, s45
    s_bfe_u32 s45, s3, 0x10006
    s_lshl_b32 s45, s45, 12
    s_add_u32 s56, s56, s45
    s_add_u32 s56, s56, 0x180000
    s_add_u32 s57, s56, 8192
    s_add_u32 m0, s43, 65536
    s_lshr_b32 s50, s2, 4
    s_lshl_b32 s50, s50, 9
    s_add_u32 s50, s50, s3
    s_cmp_eq_u32 s50, 448
    s_waitcnt lgkmcnt(0)
    s_cbranch_scc1 L_meas
L_go:
    buffer_load_dwordx4 v120, s[24:27], s56 offen offset:0 nt lds
    s_mov_b32 m0, s43
    s_load_dword s36, s[16:17], 0
    buffer_load_dwordx4 v120, s[8:11], s56 offen offset:0 nt lds
    buffer_load_dwordx4 v121, s[8:11], s56 offen offset:1024 nt lds
    buffer_load_dwordx4 v120, s[8:11], s56 offen offset:2048 nt lds
    buffer_load_dwordx4 v121, s[8:11], s56 offen offset:3072 nt lds
    s_add_u32 m0, m0, 4096
    s_nop 0
    buffer_load_dwordx4 v120, s[8:11], s57 offen offset:0 nt lds
    buffer_load_dwordx4 v121, s[8:11], s57 offen offset:1024 nt lds
    buffer_load_dwordx4 v120, s[8:11], s57 offen offset:2048 nt lds
    buffer_load_dwordx4 v121, s[8:11], s57 offen offset:3072 nt lds
    s_add_u32 m0, s43, 65536
    s_nop 0
    buffer_load_dwordx4 v121, s[24:27], s56 offen offset:1024 nt lds
    buffer_load_dwordx4 v120, s[24:27], s56 offen offset:2048 nt lds
    buffer_load_dwordx4 v121, s[24:27], s56 offen offset:3072 nt lds
    s_add_u32 m0, m0, 4096
    s_nop 0
    buffer_load_dwordx4 v120, s[24:27], s57 offen offset:0 nt lds
    buffer_load_dwordx4 v121, s[24:27], s57 offen offset:1024 nt lds
    buffer_load_dwordx4 v120, s[24:27], s57 offen offset:2048 nt lds
    buffer_load_dwordx4 v121, s[24:27], s57 offen offset:3072 nt lds
    s_branch L_c_2
L_c_38:
    s_lshr_b32 s3, s3, 6
    s_bfe_u32 s5, s2, 0x40003
    s_lshl1_add_u32 s58, s4, s6
    s_mov_b32 s18, 8388608
    s_mov_b32 s19, s11
    v_lshrrev_b32 v6, 2, v0
    v_lshlrev_b32 v6, 7, v6
    v_bfe_u32 v32, v0, 3, 2
    v_lshl_or_b32 v6, v32, 5, v6
    v_and_b32 v32, 3, v0
    v_lshl_or_b32 v6, v32, 3, v6
    s_and_b32 s40, s3, 3
    s_lshl_b32 s40, s40, 8
    s_add_u32 s40, s40, 0x24000
    v_lshlrev_b32 v82, 2, v0
    v_add_u32 v82, s40, v82
    v_bfe_u32 v83, v0, 2, 1
    v_lshlrev_b32 v83, 7, v83
    v_lshl_or_b32 v83, v1, 3, v83
    v_add_u32 v83, s40, v83
    v_bfe_u32 v39, v0, 4, 1
    v_lshlrev_b32 v39, 6, v39
    v_bfe_u32 v32, v0, 2, 2
    v_lshl_or_b32 v39, v32, 4, v39
    s_lshl_b32 s53, s4, 12
    s_lshl_b32 s45, s3, 10
    s_add_u32 s53, s53, s45
    s_add_u32 s53, s53, s46
    s_add_u32 s53, s53, 0x8000
    s_cmp_eq_u32 s7, 0
    s_cselect_b32 s54, 1.0, 0
    s_and_b32 s40, s3, 3
    s_lshl_b32 s40, s40, 5
    v_xor_b32 v112, s40, v6
    v_add_u32 v112, 131072, v112
    v_mov_b32 v56, 0
    v_mov_b32 v60, s54
    v_mov_b32 v57, 0
    v_mov_b32 v61, s54
    v_mov_b32 v58, 0
    v_mov_b32 v62, s54
    v_mov_b32 v59, 0
    v_mov_b32 v63, s54
    s_waitcnt vmcnt(3)
    v_lshlrev_b32 v32, 16, v12
    v_and_b32 v33, 0xffff0000, v12
    v_mul_f32 v34, 0xbfb8aa3b, v32
    v_mul_f32 v35, 0xbfb8aa3b, v33
    v_exp_f32 v34, v34
    v_exp_f32 v35, v35
    v_add_f32 v34, 1.0, v34
    v_add_f32 v35, 1.0, v35
    v_rcp_f32 v34, v34
    v_rcp_f32 v35, v35
    v_mul_f32 v32, v32, v34
    v_mul_f32 v33, v33, v35
    v_cvt_pk_bf16_f32 v32, v32, v33
    ds_write_b32 v82, v32
    ds_read2_b64 v[24:27], v83 offset0:0 offset1:4
    ds_read2_b64 v[28:31], v83 offset0:8 offset1:12
    v_mov_b32 v36, 0
    v_mov_b32 v37, 0
    v_mov_b32 v38, 0x3f803f80
    s_waitcnt vmcnt(0)
    v_dot2c_f32_bf16 v36, v16, v38
    v_dot2c_f32_bf16 v37, v16, v16
    v_dot2c_f32_bf16 v36, v17, v38
    v_dot2c_f32_bf16 v37, v17, v17
    v_dot2c_f32_bf16 v36, v18, v38
    v_dot2c_f32_bf16 v37, v18, v18
    v_dot2c_f32_bf16 v36, v19, v38
    v_dot2c_f32_bf16 v37, v19, v19
    v_dot2c_f32_bf16 v36, v20, v38
    v_dot2c_f32_bf16 v37, v20, v20
    v_dot2c_f32_bf16 v36, v21, v38
    v_dot2c_f32_bf16 v37, v21, v21
    v_dot2c_f32_bf16 v36, v22, v38
    v_dot2c_f32_bf16 v37, v22, v22
    v_dot2c_f32_bf16 v36, v23, v38
    v_dot2c_f32_bf16 v37, v23, v23
    s_nop 1
    v_add_f32_dpp v36, v36, v36 quad_perm:[1,0,3,2] row_mask:0xf bank_mask:0xf
    v_add_f32_dpp v37, v37, v37 quad_perm:[1,0,3,2] row_mask:0xf bank_mask:0xf
    s_nop 0
    v_add_f32_dpp v36, v36, v36 quad_perm:[2,3,0,1] row_mask:0xf bank_mask:0xf
    v_add_f32_dpp v37, v37, v37 quad_perm:[2,3,0,1] row_mask:0xf bank_mask:0xf
    s_nop 0
    v_add_f32_dpp v36, v36, v36 row_half_mirror row_mask:0xf bank_mask:0xf
    v_add_f32_dpp v37, v37, v37 row_half_mirror row_mask:0xf bank_mask:0xf
    s_nop 0
    v_add_f32_dpp v36, v36, v36 row_mirror row_mask:0xf bank_mask:0xf
    v_add_f32_dpp v37, v37, v37 row_mirror row_mask:0xf bank_mask:0xf
    v_mov_b32 v38, v36
    v_mov_b32 v35, v37
    s_nop 0
    v_permlane32_swap_b32 v36, v38
    v_permlane32_swap_b32 v37, v35
    v_add_f32 v36, v36, v38
    v_add_f32 v37, v37, v35
    v_mul_f32 v36, 0x3b000000, v36
    v_mov_b32 v38, 0x3727c5ac
    v_fmac_f32 v38, 0x3b000000, v37
    v_fma_f32 v38, -v36, v36, v38
    v_rsq_f32 v38, v38
    v_sub_f32 v13, v13, v36
    v_mul_f32 v13, v13, v38
    s_waitcnt lgkmcnt(0)
    s_add_u32 s36, s36, 0x9e3779b9
    v_mov_b32 v65, s36
    v_mov_b32 v67, s36
    v_lshl_or_b32 v4, v7, 13, v8
    s_mov_b32 s10, 4194304
    s_lshl_b32 s48, s3, 12
    s_lshl_b32 s43, s6, 8
    s_lshr_b32 s45, s48, 7
    s_add_u32 s43, s43, s45
    s_lshl_b32 s44, s43, 13
    s_lshl_b32 s45, s4, 10
    s_add_u32 s44, s44, s45
    s_add_u32 s44, s44, s46
    s_barrier
    ds_read_b64_tr_b16 v[40:41], v112 offset:0
    ds_read_b64_tr_b16 v[42:43], v112 offset:2048
    ds_read_b64_tr_b16 v[48:49], v112 offset:8192
    ds_read_b64_tr_b16 v[50:51], v112 offset:10240
    ds_read_b64_tr_b16 v[44:45], v112 offset:4096
    ds_read_b64_tr_b16 v[46:47], v112 offset:6144
    ds_read_b64_tr_b16 v[52:53], v112 offset:12288
    ds_read_b64_tr_b16 v[54:55], v112 offset:14336
    s_waitcnt lgkmcnt(6)
    v_mfma_f32_16x16x32_bf16 v[56:59], v[24:27], v[40:43], v[56:59]
    s_waitcnt lgkmcnt(4)
    v_mfma_f32_16x16x32_bf16 v[60:63], v[24:27], v[48:51], v[60:63]
    s_waitcnt lgkmcnt(2)
    v_mfma_f32_16x16x32_bf16 v[56:59], v[28:31], v[44:47], v[56:59]
    s_waitcnt lgkmcnt(0)
    v_mfma_f32_16x16x32_bf16 v[60:63], v[28:31], v[52:55], v[60:63]
    s_nop 7
    v_fma_f32 v32, v13, v60, v56
    s_nop 1
    v_mov_b32_dpp v33, v32 quad_perm:[1,1,3,3] row_mask:0xf bank_mask:0xf
    v_cvt_pk_bf16_f32 v64, v32, v33
    s_nop 1
    v_mov_b32_dpp v66, v64 quad_perm:[2,2,2,2] row_mask:0xf bank_mask:0xf
    s_mov_b32 exec_lo, 0x11111111
    s_mov_b32 exec_hi, 0x0
    buffer_store_dwordx4 v[64:67], v39, s[16:19], s53 offen sc1
    s_mov_b64 exec, -1
    s_add_u32 m0, s48, 0
    s_nop 0
    buffer_load_dwordx4 v4, s[8:11], s44 offen offset:0 nt lds
    s_add_u32 s44, s44, 64512
    buffer_load_dwordx4 v4, s[8:11], s44 offen offset:1024 nt lds
    s_add_u32 s44, s44, 64512
    buffer_load_dwordx4 v4, s[8:11], s44 offen offset:2048 nt lds
    s_add_u32 s44, s44, 64512
    buffer_load_dwordx4 v4, s[8:11], s44 offen offset:3072 nt lds
    s_load_dwordx2 s[12:13], s[0:1], 32
    s_load_dwordx2 s[32:33], s[0:1], 88
    v_lshl_or_b32 v5, v7, 10, v8
    s_mov_b32 s14, 4194304
    s_mov_b32 s15, s11
    s_movk_i32 s26, 2048
    s_branch L_B
L_meas:
    s_lshl_b32 s48, s2, 8
    s_bfe_u32 s45, s2, 0x10003
    s_lshl_b32 s45, s45, 13
    s_add_u32 s48, s48, s45
    s_add_u32 s48, s48, 0x64000
    s_xor_b32 s49, s48, 0x2000
    s_load_dword s40, s[16:17], s48 glc
    s_load_dword s41, s[16:17], s49 glc
    s_mov_b32 s38, -1
    s_mov_b32 s39, -1
    s_mov_b32 s37, 0
    s_load_dword s36, s[16:17], 0
L_ms:
    s_waitcnt lgkmcnt(0)
    s_memtime s[32:33]
    s_waitcnt lgkmcnt(0)
    s_load_dword s40, s[16:17], s48 glc
    s_waitcnt lgkmcnt(0)
    s_memtime s[34:35]
    s_waitcnt lgkmcnt(0)
    s_sub_u32 s40, s34, s32
    s_min_u32 s38, s38, s40
    s_waitcnt lgkmcnt(0)
    s_memtime s[32:33]
    s_waitcnt lgkmcnt(0)
    s_load_dword s40, s[16:17], s49 glc
    s_waitcnt lgkmcnt(0)
    s_memtime s[34:35]
    s_waitcnt lgkmcnt(0)
    s_sub_u32 s40, s34, s32
    s_min_u32 s39, s39, s40
    s_add_u32 s37, s37, 1
    s_cmp_lt_u32 s37, 3
    s_cbranch_scc1 L_ms
    s_mov_b32 s18, 8388608
    s_mov_b32 s19, s11
    s_cmp_lt_u32 s39, s38
    s_cselect_b32 s40, s49, s48
    s_lshr_b32 s40, s40, 11
    s_xor_b32 s40, s40, s2
    s_lshl_b32 s40, s40, 29
    s_and_b32 s40, s40, 0x80000000
    s_add_u32 s41, s36, 0x9e3779b9
    s_xor_b32 s40, s40, s41
    v_mov_b32 v136, s40
    s_lshl_b32 s40, s2, 2
    s_add_u32 s40, s40, 0x1800
    s_mov_b64 exec, 1
    buffer_store_dword v136, v0, s[16:19], s40 offen sc1
    s_mov_b64 exec, -1
    s_branch L_go
L_c_37:
    v_mov_b32 v32, -1
    v_mov_b32 v33, -1
    v_mov_b32 v34, -1
    v_mov_b32 v35, -1
    v_lshlrev_b32 v38, 3, v0
    s_lshl_b32 s54, s4, 14
    s_lshl_b32 s45, s7, 11
    s_add_u32 s54, s54, s45
    s_lshr_b32 s45, s40, 2
    s_add_u32 s54, s54, s45
    s_add_u32 s54, s54, 0x100000
    s_mov_b32 s18, 8388608
    s_mov_b32 s19, s11
    buffer_store_dwordx2 v[32:33], v38, s[16:19], s54 offen sc1
    v_lshl_or_b32 v37, v7, 10, v8
    s_lshl_b32 s41, s7, 14
    s_lshl1_add_u32 s41, s40, s41
    s_mov_b32 s54, s41
    s_lshl_b32 s45, s4, 7
    s_add_u32 s54, s54, s45
    s_add_u32 s54, s54, 0x40000
    s_cmp_eq_u32 s41, 126976
    s_cselect_b32 exec_hi, 0xffff, 0
    buffer_store_dwordx4 v[32:35], v37, s[16:19], s54 offen sc1
    s_mov_b64 exec, -1
L_wc:
    s_load_dwordx2 s[12:13], s[0:1], 32
    s_load_dwordx2 s[32:33], s[0:1], 88
    s_load_dword s36, s[16:17], 0
    s_lshr_b32 s3, s3, 6
    s_bfe_u32 s5, s2, 0x40003
    s_lshl1_add_u32 s58, s4, s6
    s_mov_b32 s18, 8388608
    s_mov_b32 s19, s11
    v_lshl_or_b32 v5, v7, 10, v8
    s_mov_b32 s14, 4194304
    s_mov_b32 s15, s11
    s_movk_i32 s26, 2048
    v_lshrrev_b32 v6, 2, v0
    v_lshlrev_b32 v6, 7, v6
    v_bfe_u32 v32, v0, 3, 2
    v_lshl_or_b32 v6, v32, 5, v6
    v_and_b32 v32, 3, v0
    v_lshl_or_b32 v6, v32, 3, v6
    s_and_b32 s40, s3, 3
    s_lshl_b32 s40, s40, 8
    s_add_u32 s40, s40, 0x24000
    v_lshlrev_b32 v82, 2, v0
    v_add_u32 v82, s40, v82
    v_bfe_u32 v83, v0, 2, 1
    v_lshlrev_b32 v83, 7, v83
    v_lshl_or_b32 v83, v1, 3, v83
    v_add_u32 v83, s40, v83
    s_waitcnt lgkmcnt(0)
    s_add_u32 s36, s36, 0x9e3779b9
L_B:
    s_movk_i32 s34, 2048
    s_mov_b32 s35, s11
    s_lshl_b32 s47, s4, 19
    s_lshl_b32 s45, s43, 10
    s_add_u32 s47, s47, s45
    s_add_u32 s47, s47, s46
    s_lshl_b32 s40, s3, 9
    s_add_u32 s40, s40, 0x24400
    v_lshlrev_b32 v14, 2, v0
    v_add_u32 v14, s40, v14
    s_lshl_b32 s40, s3, 8
    s_add_u32 s40, s40, 0x24400
    v_lshlrev_b32 v15, 2, v0
    v_add_u32 v15, s40, v15
    v_and_b32 v72, 7, v0
    v_lshlrev_b32 v72, 7, v72
    v_bfe_u32 v32, v0, 3, 1
    v_lshl_or_b32 v72, v32, 6, v72
    v_lshl_or_b32 v72, v1, 4, v72
    s_lshl_b32 s53, s43, 6
    s_add_u32 s53, s53, 0x8000
    v_lshrrev_b32 v73, 5, v0
    v_lshlrev_b32 v73, 12, v73
    v_and_b32 v32, 31, v0
    v_lshl_or_b32 v73, v32, 2, v73
    s_lshl_b32 s56, s4, 13
    s_lshl_b32 s45, s5, 8
    s_add_u32 s56, s56, s45
    s_lshl_b32 s45, s3, 7
    s_add_u32 s56, s56, s45
    s_add_u32 s56, s56, 0x10000
    v_add_u32 v108, s48, v6
    v_xor_b32 v109, 0x20, v108
    v_xor_b32 v110, 0x40, v108
    v_xor_b32 v111, 0x60, v108
    v_mov_b32 v77, s36
    v_mov_b32 v79, s36
    s_and_b32 s59, s4, 3
    s_lshl_b32 s59, s59, 17
    s_lshr_b32 s45, s5, 1
    s_lshl_b32 s45, s45, 14
    s_add_u32 s59, s59, s45
    s_and_b32 s45, s5, 1
    s_lshl_b32 s45, s45, 12
    s_add_u32 s59, s59, s45
    s_add_u32 s59, s59, 0x180000
    s_cmp_eq_u32 s3, 7
    s_cselect_b32 s40, 0, -1
    v_mov_b32 v118, s40
    v_mov_b32 v119, s40
    v_lshlrev_b32 v121, 3, v0
    s_lshl_b32 s99, s3, 9
    s_add_u32 s99, s99, s59
    s_bfe_u32 s45, s2, 0x10002
    s_lshl_b32 s45, s45, 13
    s_add_u32 s99, s99, s45
    v_lshlrev_b32 v8, 6, v2
    v_lshl_or_b32 v8, v1, 4, v8
    s_lshl_b32 s51, s4, 15
    s_lshl_b32 s45, s43, 6
    s_add_u32 s51, s51, s45
    s_add_u32 s51, s51, 0x80000
    s_lshl_b32 s54, s4, 10
    s_lshr_b32 s45, s43, 7
    s_lshl_b32 s45, s45, 8
    s_add_u32 s54, s54, s45
    s_add_u32 s54, s54, 0x2000
    v_lshlrev_b32 v7, 2, v1
    v_xor_b32 v7, v0, v7
    v_and_b32 v7, 7, v7
    v_lshlrev_b32 v7, 4, v7
    v_lshrrev_b32 v32, 5, v0
    v_lshl_or_b32 v7, v32, 7, v7
    v_lshrrev_b32 v81, 5, v0
    v_lshlrev_b32 v81, 6, v81
    v_bfe_u32 v32, v0, 2, 2
    v_lshl_or_b32 v81, v32, 4, v81
    v_bfe_u32 v32, v0, 4, 1
    v_lshl_or_b32 v81, v32, 3, v81
    s_lshr_b32 s60, s7, 2
    s_lshl_b32 s60, s60, 14
    s_and_b32 s45, s7, 3
    s_lshl_b32 s45, s45, 11
    s_add_u32 s60, s60, s45
    s_and_b32 s45, s3, 1
    s_lshl_b32 s45, s45, 10
    s_add_u32 s60, s60, s45
    s_lshl_b32 s45, s6, 15
    s_add_u32 s60, s60, s45
    s_lshl_b32 s45, s4, 7
    s_add_u32 s60, s60, s45
    s_add_u32 s60, s60, 0x40000
    s_add_u32 s52, s60, 65536
    s_add_u32 s100, s60, 8192
    s_add_u32 s101, s52, 8192
    v_and_b32 v32, 1, v0
    v_lshlrev_b32 v32, 4, v32
    v_mov_b32 v33, 0x3f80
    v_lshlrev_b32 v32, v32, v33
    v_lshrrev_b32 v33, 2, v2
    v_sub_u32 v33, v1, v33
    v_bfe_u32 v34, v0, 1, 1
    v_lshl_or_b32 v33, v33, 1, v34
    v_cmp_eq_u32 vcc, 0, v33
    v_mov_b32 v86, 0
    v_mov_b32 v88, 0
    v_cndmask_b32 v84, 0, v32, vcc
    v_cndmask_b32 v90, 0, v32, vcc
    v_cmp_eq_u32 vcc, 1, v33
    v_mov_b32 v87, 0
    v_mov_b32 v89, 0
    v_cndmask_b32 v85, 0, v32, vcc
    v_cndmask_b32 v91, 0, v32, vcc
    v_and_b32 v38, 1, v0
    v_lshlrev_b32 v38, 3, v38
    v_lshrrev_b32 v33, 5, v0
    v_lshl_or_b32 v38, v33, 1, v38
    v_bfe_u32 v33, v0, 4, 1
    v_lshl_or_b32 v38, v33, 2, v38
    s_and_b32 s40, s5, 3
    s_lshl_b32 s40, s40, 4
    v_add_u32 v114, s40, v38
    v_lshlrev_b32 v116, 4, v0
    s_lshl_b32 s49, s6, 14
    s_lshl_b32 s45, s7, 10
    s_add_u32 s49, s49, s45
    s_add_u32 s49, s49, 0x40000
    s_lshl_b32 s55, s4, 7
    s_and_b32 s45, s7, 3
    s_lshl_b32 s45, s45, 5
    s_add_u32 s55, s55, s45
    s_lshr_b32 s45, s7, 2
    s_lshl_b32 s45, s45, 10
    s_add_u32 s55, s55, s45
    s_lshl3_add_u32 s55, s6, s55
    s_add_u32 s55, s55, 0x60000
    v_lshrrev_b32 v113, 5, v0
    v_lshlrev_b32 v113, 4, v113
    v_bfe_u32 v33, v0, 4, 1
    v_lshl_or_b32 v113, v33, 2, v113
    s_lshl_b32 s61, s7, 12
    s_lshl_b32 s45, s3, 11
    s_add_u32 s61, s61, s45
    s_add_u32 s61, s61, 0x20000
    s_and_b32 s40, s4, 3
    s_lshl_b32 s40, s40, 13
    s_lshr_b32 s45, s5, 2
    s_lshl_b32 s45, s45, 11
    s_add_u32 s40, s40, s45
    s_add_u32 s40, s40, 0x38000
    s_cmp_eq_u32 s3, 2
    s_cselect_b32 s61, s40, s61
    s_cselect_b32 s40, 0, 0x10000
    s_add_u32 s63, s61, s40
    v_lshrrev_b32 v120, 5, v0
    v_lshlrev_b32 v120, 10, v120
    v_and_b32 v33, 31, v0
    v_lshl_or_b32 v120, v33, 1, v120
    s_lshl_b32 s42, s7, 7
    s_lshl_b32 s45, s3, 6
    s_add_u32 s42, s42, s45
    v_mov_b32 v80, 0
    v_lshrrev_b32 v39, 5, v0
    v_lshlrev_b32 v39, 12, v39
    v_bfe_u32 v32, v0, 4, 1
    v_lshl_or_b32 v39, v32, 6, v39
    v_bfe_u32 v32, v0, 2, 2
    v_lshl_or_b32 v39, v32, 4, v39
    s_lshl_b32 s41, s4, 15
    s_lshl_b32 s45, s5, 11
    s_add_u32 s41, s41, s45
    s_add_u32 s41, s41, 0x80000
    v_lshlrev_b32 v10, 7, v2
    v_lshlrev_b32 v117, 10, v1
    s_lshl_b32 s57, s4, 19
    s_lshl_b32 s45, s5, 15
    s_add_u32 s57, s57, s45
    s_lshl_b32 s45, s3, 12
    s_add_u32 s57, s57, s45
    s_add_u32 s57, s57, 0x180
    v_lshlrev_b32 v122, 2, v2
    s_cmp_eq_u32 s6, 0
    s_cbranch_scc1 L_nmb_40
    s_lshl_b32 s96, s4, 13
    s_lshr_b32 s45, s3, 2
    s_lshl_b32 s45, s45, 16
    s_add_u32 s96, s96, s45
    s_and_b32 s45, s3, 3
    s_lshl_b32 s45, s45, 10
    s_add_u32 s96, s96, s45
    s_add_u32 s96, s96, s46
    s_add_u32 s96, s96, 0x20000
    s_bfe_u32 s40, s4, 0x10002
    s_lshl_b32 s40, s40, 3
    s_lshr_b32 s45, s3, 2
    s_lshl4_add_u32 s40, s45, s40
    s_add_u32 s40, s40, s7
    s_cmp_eq_u32 s40, 16
    s_cselect_b32 s97, 1.0, 0
    s_lshr_b32 s98, s3, 2
    s_lshl_b32 s98, s98, 14
    s_add_u32 s98, s98, 0x10000
    s_and_b32 s40, s3, 3
    s_lshl_b32 s40, s40, 5
    v_xor_b32 v112, s40, v6
    v_add_u32 v112, s98, v112
    v_mov_b32 v56, s97
    v_mov_b32 v60, s97
    v_mov_b32 v57, s97
    v_mov_b32 v61, s97
    v_mov_b32 v58, s97
    v_mov_b32 v62, s97
    v_mov_b32 v59, s97
    v_mov_b32 v63, s97
    v_mov_b32 v65, s36
    v_mov_b32 v67, s36
    s_waitcnt vmcnt(4)
    v_lshlrev_b32 v32, 16, v12
    v_and_b32 v33, 0xffff0000, v12
    v_mul_f32 v34, 0xbfb8aa3b, v32
    v_mul_f32 v35, 0xbfb8aa3b, v33
    v_exp_f32 v34, v34
    v_exp_f32 v35, v35
    v_add_f32 v34, 1.0, v34
    v_add_f32 v35, 1.0, v35
    v_rcp_f32 v34, v34
    v_rcp_f32 v35, v35
    v_mul_f32 v32, v32, v34
    v_mul_f32 v33, v33, v35
    v_cvt_pk_bf16_f32 v32, v32, v33
    ds_write_b32 v82, v32
    ds_read2_b64 v[24:27], v83 offset0:0 offset1:4
    ds_read2_b64 v[28:31], v83 offset0:8 offset1:12
    s_waitcnt vmcnt(1)
    buffer_load_dwordx4 v[16:19], v72, s[16:19], s53 offen sc1
    buffer_load_dwordx4 v[20:23], v72, s[16:19], s53 offen offset:1024 sc1
    s_waitcnt vmcnt(2) lgkmcnt(0)
    s_barrier
    ds_read_b64_tr_b16 v[40:41], v112 offset:0
    ds_read_b64_tr_b16 v[42:43], v112 offset:2048
    ds_read_b64_tr_b16 v[48:49], v112 offset:8192
    ds_read_b64_tr_b16 v[50:51], v112 offset:10240
    ds_read_b64_tr_b16 v[44:45], v112 offset:4096
    ds_read_b64_tr_b16 v[46:47], v112 offset:6144
    ds_read_b64_tr_b16 v[52:53], v112 offset:12288
    ds_read_b64_tr_b16 v[54:55], v112 offset:14336
    s_waitcnt lgkmcnt(6)
    v_mfma_f32_16x16x32_bf16 v[56:59], v[24:27], v[40:43], v[56:59]
    s_waitcnt lgkmcnt(4)
    v_mfma_f32_16x16x32_bf16 v[60:63], v[24:27], v[48:51], v[60:63]
    s_waitcnt lgkmcnt(2)
    v_mfma_f32_16x16x32_bf16 v[56:59], v[28:31], v[44:47], v[56:59]
    s_waitcnt lgkmcnt(0)
    v_mfma_f32_16x16x32_bf16 v[60:63], v[28:31], v[52:55], v[60:63]
    v_cmp_gt_u32 vcc, 32, v0
    s_nop 6
    v_cndmask_b32 v32, v60, v56, vcc
    ds_read_b64_tr_b16 v[40:41], v108 offset:0
    ds_read_b64_tr_b16 v[42:43], v108 offset:2048
    ds_read_b64_tr_b16 v[44:45], v109 offset:0
    ds_read_b64_tr_b16 v[46:47], v109 offset:2048
    ds_read_b64_tr_b16 v[48:49], v110 offset:0
    ds_read_b64_tr_b16 v[50:51], v110 offset:2048
    ds_read_b64_tr_b16 v[52:53], v111 offset:0
    ds_read_b64_tr_b16 v[54:55], v111 offset:2048
    v_mov_b32_dpp v34, v32 quad_perm:[1,1,3,3] row_mask:0xf bank_mask:0xf
    v_cvt_pk_bf16_f32 v64, v32, v34
    s_nop 1
    v_mov_b32_dpp v66, v64 quad_perm:[2,2,2,2] row_mask:0xf bank_mask:0xf
    s_mov_b32 exec_lo, 0x11111111
    s_mov_b32 exec_hi, 0x11111111
    buffer_store_dwordx4 v[64:67], v39, s[16:19], s96 offen sc1
    s_mov_b64 exec, -1
    s_branch L_nmc_41
L_nmb_40:
    s_cmp_lt_u32 s3, 4
    s_cbranch_scc1 L_ntk_42
    s_lshl_b32 s40, s4, 10
    s_add_u32 s40, s40, s46
    s_lshl2_add_u32 s40, s3, s40
    s_add_u32 s40, s40, 0x3ff0
    s_waitcnt vmcnt(0)
    s_mov_b64 exec, 1
    buffer_store_dword v77, v0, s[16:19], s40 offen sc1
    s_mov_b64 exec, -1
L_ntk_42:
    s_waitcnt vmcnt(1)
    buffer_load_dwordx4 v[16:19], v72, s[16:19], s53 offen sc1
    buffer_load_dwordx4 v[20:23], v72, s[16:19], s53 offen offset:1024 sc1
    s_waitcnt vmcnt(2)
    ds_read_b64_tr_b16 v[40:41], v108 offset:0
    ds_read_b64_tr_b16 v[42:43], v108 offset:2048
    ds_read_b64_tr_b16 v[44:45], v109 offset:0
    ds_read_b64_tr_b16 v[46:47], v109 offset:2048
    ds_read_b64_tr_b16 v[48:49], v110 offset:0
    ds_read_b64_tr_b16 v[50:51], v110 offset:2048
    ds_read_b64_tr_b16 v[52:53], v111 offset:0
    ds_read_b64_tr_b16 v[54:55], v111 offset:2048
    s_waitcnt vmcnt(0)
L_nmc_41:
    s_mov_b32 s37, 0
    s_waitcnt vmcnt(1)
    s_branch L_chk_45
L_again_43:
    s_sleep 1
    s_add_u32 s37, s37, 1
    s_and_b32 s45, s37, 255
    s_cbranch_scc1 L_poll_44
    buffer_wbl2 sc1
    s_cmp_ge_u32 s37, 200000
    s_cbranch_scc1 L_got_46
L_poll_44:
    buffer_load_dwordx4 v[16:19], v72, s[16:19], s53 offen sc1
    buffer_load_dwordx4 v[20:23], v72, s[16:19], s53 offen offset:1024 sc1
L_poll_44w:
    s_waitcnt vmcnt(0)
L_chk_45:
    v_xor_b32 v33, s36, v17
    v_bitop3_b32 v33, v19, s36, v33 bitop3:0xbe
    v_bitop3_b32 v33, v21, s36, v33 bitop3:0xbe
    v_bitop3_b32 v33, v23, s36, v33 bitop3:0xbe
    v_cmp_ne_u32 vcc, 0, v33
    s_cbranch_vccnz L_again_43
L_got_46:
    v_mov_b32 v17, v18
    v_mov_b32 v18, v20
    v_mov_b32 v19, v22
    s_waitcnt lgkmcnt(0)
    s_nop 0
    v_mfma_f32_16x16x32_bf16 v[56:59], v[16:19], v[40:43], 0
    v_mfma_f32_16x16x32_bf16 v[60:63], v[16:19], v[44:47], 0
    v_mfma_f32_16x16x32_bf16 v[64:67], v[16:19], v[48:51], 0
    v_mfma_f32_16x16x32_bf16 v[68:71], v[16:19], v[52:55], 0
    s_nop 4
    v_add_f32 v56, v56, v57
    v_add_f32 v58, v58, v59
    v_add_f32 v60, v60, v61
    v_add_f32 v62, v62, v63
    v_add_f32 v64, v64, v65
    v_add_f32 v66, v66, v67
    v_add_f32 v68, v68, v69
    v_add_f32 v70, v70, v71
    v_add_f32 v56, v56, v58
    v_add_f32 v60, v60, v62
    v_add_f32 v64, v64, v66
    v_add_f32 v68, v68, v70
    v_permlane16_swap_b32 v56, v60
    s_nop 0
    v_permlane16_swap_b32 v64, v68
    v_add_f32 v56, v56, v60
    v_add_f32 v64, v64, v68
    ds_write2st64_b32 v14, v56, v64 offset0:0 offset1:1
    s_cmp_ge_u32 s3, 2
    s_waitcnt lgkmcnt(0)
    s_barrier
    s_cbranch_scc1 L_nq_47
    ds_read2st64_b32 v[32:33], v15 offset0:0 offset1:2
    ds_read2st64_b32 v[34:35], v15 offset0:4 offset1:6
    ds_read2st64_b32 v[36:37], v15 offset0:8 offset1:10
    ds_read2st64_b32 v[38:39], v15 offset0:12 offset1:14
    s_waitcnt lgkmcnt(2)
    v_add_f32 v32, v32, v33
    v_add_f32 v34, v34, v35
    v_add_f32 v32, v32, v34
    s_waitcnt lgkmcnt(0)
    v_add_f32 v36, v36, v37
    v_add_f32 v38, v38, v39
    v_add_f32 v36, v36, v38
    v_add_f32 v32, v32, v36
    s_nop 1
    v_mov_b32_dpp v33, v32 quad_perm:[1,1,3,3] row_mask:0xf bank_mask:0xf
    v_cvt_pk_bf16_f32 v76, v32, v33
    s_nop 1
    v_mov_b32_dpp v78, v76 quad_perm:[2,2,2,2] row_mask:0xf bank_mask:0xf
    s_mov_b32 exec_lo, 0x11111111
    s_mov_b32 exec_hi, 0x11111111
    buffer_store_dwordx4 v[76:79], v73, s[16:19], s56 offen
    s_mov_b64 exec, -1
L_nq_47:
    s_add_u32 m0, s48, 32768
    s_barrier
    s_cmp_ge_u32 s3, 3
    s_cbranch_scc1 L_nc0_48
    buffer_load_dwordx4 v[128:131], v72, s[16:19], s61 offen sc1
    buffer_load_dwordx4 v[132:135], v72, s[16:19], s61 offen offset:1024 sc1
    buffer_load_dwordx4 v[136:139], v72, s[16:19], s63 offen sc1
    buffer_load_dwordx4 v[140:143], v72, s[16:19], s63 offen offset:1024 sc1
    s_cmp_lg_u32 s58, 0
    s_cbranch_scc1 L_nc3_49
    buffer_load_short_d16_hi v80, v120, s[24:27], s42 offen
    s_branch L_nc3_49
L_nc0_48:
    s_cmp_lg_u32 s3, 3
    s_cbranch_scc1 L_nc3_49
    buffer_load_dword v11, v10, s[16:19], s41 offen sc1
    s_lshl_b32 s40, s4, 10
    s_add_u32 s40, s40, 0x2000
    buffer_load_dword v11, v116, s[16:19], s40 offen sc1
L_nc3_49:
    buffer_store_dwordx2 v[118:119], v121, s[16:19], s99 offen sc1
    buffer_load_dword v11, v117, s[12:15], s57 offen
    buffer_load_dwordx4 v5, s[12:15], s47 offen offset:0 nt lds
    s_add_u32 s47, s47, 7168
    buffer_load_dwordx4 v5, s[12:15], s47 offen offset:1024 nt lds
    s_add_u32 s47, s47, 7168
    buffer_load_dwordx4 v5, s[12:15], s47 offen offset:2048 nt lds
    s_add_u32 s47, s47, 7168
    buffer_load_dwordx4 v5, s[12:15], s47 offen offset:3072 nt lds
    s_cmp_ge_u32 s3, 3
    s_cbranch_scc1 L_nc1_50
    s_mov_b32 s37, 0
    s_waitcnt vmcnt(4)
    s_branch L_chk_53
L_again_51:
    s_sleep 2
    s_add_u32 s37, s37, 1
    s_and_b32 s45, s37, 255
    s_cbranch_scc1 L_poll_52
    buffer_wbl2 sc1
    s_cmp_ge_u32 s37, 200000
    s_cbranch_scc1 L_got_54
L_poll_52:
    buffer_load_dwordx4 v[128:131], v72, s[16:19], s61 offen sc1
    buffer_load_dwordx4 v[132:135], v72, s[16:19], s61 offen offset:1024 sc1
    buffer_load_dwordx4 v[136:139], v72, s[16:19], s63 offen sc1
    buffer_load_dwordx4 v[140:143], v72, s[16:19], s63 offen offset:1024 sc1
L_poll_52w:
    s_waitcnt vmcnt(0)
L_chk_53:
    v_xor_b32 v33, s36, v129
    v_bitop3_b32 v33, v131, s36, v33 bitop3:0xbe
    v_bitop3_b32 v33, v133, s36, v33 bitop3:0xbe
    v_bitop3_b32 v33, v135, s36, v33 bitop3:0xbe
    v_bitop3_b32 v33, v137, s36, v33 bitop3:0xbe
    v_bitop3_b32 v33, v139, s36, v33 bitop3:0xbe
    v_bitop3_b32 v33, v141, s36, v33 bitop3:0xbe
    v_bitop3_b32 v33, v143, s36, v33 bitop3:0xbe
    v_cmp_ne_u32 vcc, 0, v33
    s_cbranch_vccnz L_again_51
L_got_54:
    v_mov_b32 v129, v130
    v_mov_b32 v130, v132
    v_mov_b32 v131, v134
    v_mov_b32 v137, v138
    v_mov_b32 v138, v140
    v_mov_b32 v139, v142
    v_mfma_f32_16x16x32_bf16 v[56:59], v[128:131], v[84:87], 0
    v_mfma_f32_16x16x32_bf16 v[60:63], v[128:131], v[88:91], 0
    v_mfma_f32_16x16x32_bf16 v[64:67], v[136:139], v[84:87], 0
    v_mfma_f32_16x16x32_bf16 v[68:71], v[136:139], v[88:91], 0
    s_nop 4
    v_add_f32 v56, v56, v57
    v_add_f32 v58, v58, v59
    v_add_f32 v60, v60, v61
    v_add_f32 v62, v62, v63
    v_add_f32 v64, v64, v65
    v_add_f32 v66, v66, v67
    v_add_f32 v68, v68, v69
    v_add_f32 v70, v70, v71
    v_add_f32 v56, v56, v58
    v_add_f32 v60, v60, v62
    v_add_f32 v64, v64, v66
    v_add_f32 v68, v68, v70
    v_permlane16_swap_b32 v56, v60
    s_nop 0
    v_permlane16_swap_b32 v64, v68
    v_add_f32 v74, v56, v60
    v_add_f32 v75, v64, v68
L_nc1_50:
    s_waitcnt vmcnt(0)
    ds_read_b64_tr_b16 v[40:41], v108 offset:32768
    ds_read_b64_tr_b16 v[42:43], v108 offset:34816
    ds_read_b64_tr_b16 v[44:45], v109 offset:32768
    ds_read_b64_tr_b16 v[46:47], v109 offset:34816
    ds_read_b64_tr_b16 v[48:49], v110 offset:32768
    ds_read_b64_tr_b16 v[50:51], v110 offset:34816
    ds_read_b64_tr_b16 v[52:53], v111 offset:32768
    ds_read_b64_tr_b16 v[54:55], v111 offset:34816
    s_mov_b32 s37, 0
L_aw_55:
    buffer_load_dwordx4 v[16:19], v7, s[16:19], s54 offen sc1
    s_waitcnt vmcnt(0)
    v_cmp_eq_u32 vcc, s36, v19
    s_cbranch_vccnz L_awd_56
    s_sleep 6
    s_add_u32 s37, s37, 1
    s_cmp_lt_u32 s37, 64
    s_cbranch_scc1 L_aw_55
L_awd_56:
    s_mov_b32 s37, 0
    s_branch L_poll_58w
L_again_57:
    s_sleep 2
    s_add_u32 s37, s37, 1
    s_and_b32 s45, s37, 255
    s_cbranch_scc1 L_poll_58
    buffer_wbl2 sc1
    s_cmp_ge_u32 s37, 200000
    s_cbranch_scc1 L_got_60
L_poll_58:
    buffer_load_dwordx4 v[16:19], v7, s[16:19], s54 offen sc1
L_poll_58w:
    s_waitcnt vmcnt(0)
L_chk_59:
    v_xor_b32 v33, s36, v17
    v_bitop3_b32 v33, v19, s36, v33 bitop3:0xbe
    v_cmp_ne_u32 vcc, 0, v33
    s_cbranch_vccnz L_again_57
L_got_60:
    buffer_load_dwordx4 v[24:27], v8, s[16:19], s51 offen sc1
    buffer_load_dwordx4 v[28:31], v8, s[16:19], s51 offen offset:1024 sc1
    v_max_f32_dpp v17, v16, v16 quad_perm:[1,0,3,2] row_mask:0xf bank_mask:0xf
    s_nop 1
    v_max_f32_dpp v17, v17, v17 quad_perm:[2,3,0,1] row_mask:0xf bank_mask:0xf
    s_nop 1
    v_max_f32_dpp v17, v17, v17 row_half_mirror row_mask:0xf bank_mask:0xf
    v_sub_f32 v16, v16, v17
    v_exp_f32 v16, v16
    s_nop 0
    v_mul_f32 v17, v16, v18
    s_nop 1
    v_add_f32_dpp v17, v17, v17 quad_perm:[1,0,3,2] row_mask:0xf bank_mask:0xf
    s_nop 1
    v_add_f32_dpp v17, v17, v17 quad_perm:[2,3,0,1] row_mask:0xf bank_mask:0xf
    s_nop 1
    v_add_f32_dpp v17, v17, v17 row_half_mirror row_mask:0xf bank_mask:0xf
    v_rcp_f32 v17, v17
    s_nop 0
    v_mul_f32 v100, v16, v17
    s_waitcnt lgkmcnt(0)
    s_mov_b32 s37, 0
    s_branch L_poll_62w
L_again_61:
    s_add_u32 s37, s37, 1
    s_and_b32 s45, s37, 255
    s_cbranch_scc1 L_poll_62
    buffer_wbl2 sc1
    s_cmp_ge_u32 s37, 200000
    s_cbranch_scc1 L_got_64
L_poll_62:
    buffer_load_dwordx4 v[24:27], v8, s[16:19], s51 offen sc1
    buffer_load_dwordx4 v[28:31], v8, s[16:19], s51 offen offset:1024 sc1
L_poll_62w:
    s_waitcnt vmcnt(0)
L_chk_63:
    v_xor_b32 v33, s36, v25
    v_bitop3_b32 v33, v27, s36, v33 bitop3:0xbe
    v_bitop3_b32 v33, v29, s36, v33 bitop3:0xbe
    v_bitop3_b32 v33, v31, s36, v33 bitop3:0xbe
    v_cmp_ne_u32 vcc, 0, v33
    s_cbranch_vccnz L_again_61
L_got_64:
    v_mov_b32 v25, v26
    v_mov_b32 v26, v28
    v_mov_b32 v27, v30
    s_nop 1
    v_mfma_f32_16x16x32_bf16 v[56:59], v[24:27], v[40:43], 0
    v_mfma_f32_16x16x32_bf16 v[60:63], v[24:27], v[44:47], 0
    v_mfma_f32_16x16x32_bf16 v[64:67], v[24:27], v[48:51], 0
    v_mfma_f32_16x16x32_bf16 v[68:71], v[24:27], v[52:55], 0
    s_nop 4
    v_mul_f32_dpp v56, v100, v56 row_newbcast:0 row_mask:0xf bank_mask:0xf
    v_mul_f32_dpp v60, v100, v60 row_newbcast:0 row_mask:0xf bank_mask:0xf
    v_mul_f32_dpp v64, v100, v64 row_newbcast:0 row_mask:0xf bank_mask:0xf
    v_mul_f32_dpp v68, v100, v68 row_newbcast:0 row_mask:0xf bank_mask:0xf
    v_fmac_f32_dpp v56, v100, v57 row_newbcast:1 row_mask:0xf bank_mask:0xf
    v_fmac_f32_dpp v60, v100, v61 row_newbcast:1 row_mask:0xf bank_mask:0xf
    v_fmac_f32_dpp v64, v100, v65 row_newbcast:1 row_mask:0xf bank_mask:0xf
    v_fmac_f32_dpp v68, v100, v69 row_newbcast:1 row_mask:0xf bank_mask:0xf
    v_fmac_f32_dpp v56, v100, v58 row_newbcast:2 row_mask:0xf bank_mask:0xf
    v_fmac_f32_dpp v60, v100, v62 row_newbcast:2 row_mask:0xf bank_mask:0xf
    v_fmac_f32_dpp v64, v100, v66 row_newbcast:2 row_mask:0xf bank_mask:0xf
    v_fmac_f32_dpp v68, v100, v70 row_newbcast:2 row_mask:0xf bank_mask:0xf
    v_fmac_f32_dpp v56, v100, v59 row_newbcast:3 row_mask:0xf bank_mask:0xf
    v_fmac_f32_dpp v60, v100, v63 row_newbcast:3 row_mask:0xf bank_mask:0xf
    v_fmac_f32_dpp v64, v100, v67 row_newbcast:3 row_mask:0xf bank_mask:0xf
    v_fmac_f32_dpp v68, v100, v71 row_newbcast:3 row_mask:0xf bank_mask:0xf
    v_permlane16_swap_b32 v56, v60
    s_nop 0
    v_permlane16_swap_b32 v64, v68
    v_add_f32 v56, v56, v60
    v_add_f32 v64, v64, v68
    ds_write2st64_b32 v14, v56, v64 offset0:0 offset1:1
    s_cmp_ge_u32 s3, 2
    s_waitcnt lgkmcnt(0)
    s_barrier
    s_cbranch_scc1 L_fin
    ds_read2st64_b32 v[32:33], v15 offset0:0 offset1:2
    ds_read2st64_b32 v[34:35], v15 offset0:4 offset1:6
    ds_read2st64_b32 v[36:37], v15 offset0:8 offset1:10
    ds_read2st64_b32 v[38:39], v15 offset0:12 offset1:14
    s_waitcnt lgkmcnt(2)
    v_add_f32 v32, v32, v33
    v_add_f32 v34, v34, v35
    v_add_f32 v32, v32, v34
    s_waitcnt lgkmcnt(0)
    v_add_f32 v36, v36, v37
    v_add_f32 v38, v38, v39
    v_add_f32 v36, v36, v38
    v_add_f32 v32, v32, v36
    v_fma_f32 v32, v32, v74, v80
    v_mul_f32 v36, v32, v75
    s_nop 0
    v_mov_b32_dpp v33, v32 quad_perm:[1,1,3,3] row_mask:0xf bank_mask:0xf
    v_mov_b32_dpp v37, v36 quad_perm:[1,1,3,3] row_mask:0xf bank_mask:0xf
    v_cvt_pk_bf16_f32 v34, v32, v33
    v_cvt_pk_bf16_f32 v38, v36, v37
    s_nop 0
    v_mov_b32_dpp v35, v34 quad_perm:[2,2,2,2] row_mask:0xf bank_mask:0xf
    v_mov_b32_dpp v39, v38 quad_perm:[2,2,2,2] row_mask:0xf bank_mask:0xf
    s_mov_b32 exec_lo, 0x11111111
    s_mov_b32 exec_hi, 0x11111111
    buffer_store_dwordx2 v[38:39], v81, s[16:19], s52 offen sc1
    buffer_store_dwordx2 v[38:39], v81, s[16:19], s101 offen sc1
    buffer_store_dwordx2 v[34:35], v81, s[16:19], s60 offen sc1
    buffer_store_dwordx2 v[34:35], v81, s[16:19], s100 offen sc1
    s_branch L_exit
L_fin:
    s_cmp_gt_u32 s3, 2
    s_cbranch_scc1 L_exit
    v_lshlrev_b32 v32, 7, v0
    s_movk_i32 s40, 16384
    s_movk_i32 s41, 6144
    s_mov_b32 s37, 0
    s_branch L_poll_66
L_again_65:
    s_sleep 2
    s_add_u32 s37, s37, 1
    s_and_b32 s45, s37, 255
    s_cbranch_scc1 L_poll_66
    buffer_wbl2 sc1
    s_cmp_ge_u32 s37, 200000
    s_cbranch_scc1 L_got_68
L_poll_66:
    buffer_load_dwordx4 v[16:19], v32, s[16:19], s40 offen sc1
    buffer_load_dword v20, v122, s[16:19], s41 offen sc1
L_poll_66w:
    s_waitcnt vmcnt(0)
L_chk_67:
    v_xor_b32 v33, s36, v20
    v_lshlrev_b32 v33, 1, v33
    v_bitop3_b32 v33, v16, s36, v33 bitop3:0xbe
    v_bitop3_b32 v33, v17, s36, v33 bitop3:0xbe
    v_bitop3_b32 v33, v18, s36, v33 bitop3:0xbe
    v_bitop3_b32 v33, v19, s36, v33 bitop3:0xbe
    v_cmp_ne_u32 vcc, 0, v33
    s_cbranch_vccnz L_again_65
L_got_68:
    s_xor_b32 s44, s36, 0x80000000
    v_cmp_eq_u32 vcc, s44, v20
    s_bcnt1_i32_b32 s45, vcc_lo
    v_cmp_eq_u32 vcc, s36, v20
    s_bcnt1_i32_b32 s44, vcc_lo
    s_cmp_gt_u32 s45, s44
    s_cselect_b32 s44, 4, 0
    s_xor_b32 s44, s44, s2
    s_and_b32 s44, s44, 4
    s_lshl_b32 s44, s44, 11
    s_add_u32 s49, s49, s44
    s_add_u32 s50, s49, 32768
    s_add_u32 s59, s59, s44
    s_mov_b32 s37, 0
    s_branch L_poll_70
L_again_69:
    s_add_u32 s37, s37, 1
    s_and_b32 s45, s37, 255
    s_cbranch_scc1 L_poll_70
    buffer_wbl2 sc1
    s_cmp_ge_u32 s37, 200000
    s_cbranch_scc1 L_got_72
L_poll_70:
    buffer_load_dwordx4 v[16:19], v72, s[16:19], s49 offen sc1
    buffer_load_dwordx4 v[20:23], v72, s[16:19], s50 offen sc1
L_poll_70w:
    s_waitcnt vmcnt(0)
L_chk_71:
    v_max3_u32 v33, v16, v17, v18
    v_max3_u32 v34, v19, v20, v21
    v_max3_u32 v33, v33, v22, v23
    v_max_u32 v33, v33, v34
    v_cmp_eq_u32 vcc, -1, v33
    s_cbranch_vccnz L_again_69
L_got_72:
    v_mfma_f32_16x16x32_bf16 v[56:59], v[16:19], v[84:87], 0
    v_mfma_f32_16x16x32_bf16 v[60:63], v[16:19], v[88:91], 0
    v_mfma_f32_16x16x32_bf16 v[56:59], v[20:23], v[84:87], v[56:59]
    v_mfma_f32_16x16x32_bf16 v[60:63], v[20:23], v[88:91], v[60:63]
    s_nop 6
    v_add_f32 v56, v56, v57
    v_add_f32 v58, v58, v59
    v_add_f32 v60, v60, v61
    v_add_f32 v62, v62, v63
    v_add_f32 v56, v56, v58
    v_add_f32 v60, v60, v62
    s_nop 1
    v_permlane16_swap_b32 v56, v60
    v_add_f32 v42, v56, v60
    v_add_f32 v43, v56, v60
    v_mul_f32 v44, v42, v42
    s_nop 1
    v_permlane16_swap_b32 v43, v44
    v_add_f32 v76, v43, v44
    s_nop 1
    v_add_f32_dpp v76, v76, v76 quad_perm:[1,0,3,2] row_mask:0xf bank_mask:0xf
    s_nop 1
    v_add_f32_dpp v76, v76, v76 quad_perm:[2,3,0,1] row_mask:0xf bank_mask:0xf
    s_nop 1
    v_add_f32_dpp v76, v76, v76 row_half_mirror row_mask:0xf bank_mask:0xf
    s_nop 1
    v_add_f32_dpp v76, v76, v76 row_mirror row_mask:0xf bank_mask:0xf
    s_mov_b32 exec_lo, 0x10001
    s_mov_b32 exec_hi, 0x10001
    buffer_store_dword v76, v113, s[16:19], s55 offen
    s_mov_b64 exec, -1
    s_lshr_b32 s40, s44, 6
    v_lshl_add_u32 v115, v114, 1, s40
    s_lshr_b32 s62, s44, 3
    s_and_b32 s45, s4, 3
    s_lshl_b32 s45, s45, 8
    s_add_u32 s62, s62, s45
    s_lshr_b32 s45, s5, 2
    s_lshl_b32 s45, s45, 6
    s_add_u32 s62, s62, s45
    s_bfe_u32 s49, s4, 0x10001
    s_lshl_b32 s49, s49, 14
    s_and_b32 s45, s4, 1
    s_lshl_b32 s45, s45, 12
    s_add_u32 s49, s49, s45
    s_lshr_b32 s45, s5, 2
    s_lshl_b32 s45, s45, 10
    s_add_u32 s49, s49, s45
    s_add_u32 s49, s49, s44
    s_add_u32 s49, s49, 0x40000
    s_add_u32 s50, s49, 32768
    s_mov_b32 s37, 0
    s_branch L_poll_74
L_again_73:
    s_sleep 1
    s_add_u32 s37, s37, 1
    s_and_b32 s45, s37, 255
    s_cbranch_scc1 L_poll_74
    buffer_wbl2 sc1
    s_cmp_ge_u32 s37, 200000
    s_cbranch_scc1 L_got_76
L_poll_74:
    buffer_load_dwordx4 v[16:19], v72, s[16:19], s49 offen sc1
    buffer_load_dwordx4 v[20:23], v72, s[16:19], s50 offen sc1
L_poll_74w:
    s_waitcnt vmcnt(0)
L_chk_75:
    v_max3_u32 v33, v16, v17, v18
    v_max3_u32 v34, v19, v20, v21
    v_max3_u32 v33, v33, v22, v23
    v_max_u32 v33, v33, v34
    v_cmp_eq_u32 vcc, -1, v33
    s_cbranch_vccnz L_again_73
L_got_76:
    v_mfma_f32_16x16x32_bf16 v[56:59], v[16:19], v[84:87], 0
    v_mfma_f32_16x16x32_bf16 v[60:63], v[16:19], v[88:91], 0
    v_mfma_f32_16x16x32_bf16 v[56:59], v[20:23], v[84:87], v[56:59]
    v_mfma_f32_16x16x32_bf16 v[60:63], v[20:23], v[88:91], v[60:63]
    s_nop 6
    v_add_f32 v56, v56, v57
    v_add_f32 v58, v58, v59
    v_add_f32 v60, v60, v61
    v_add_f32 v62, v62, v63
    v_add_f32 v56, v56, v58
    v_add_f32 v60, v60, v62
    s_nop 1
    v_permlane16_swap_b32 v56, v60
    v_add_f32 v42, v56, v60
    ds_bpermute_b32 v42, v115, v42
    ds_bpermute_b32 v74, v115, v74
    s_xor_b32 s40, s60, 512
    s_add_u32 s40, s40, s44
    v_mov_b32 v32, 0
    s_mov_b32 s37, 0
    s_branch L_poll_78
L_again_77:
    s_sleep 1
    s_add_u32 s37, s37, 1
    s_and_b32 s45, s37, 255
    s_cbranch_scc1 L_poll_78
    buffer_wbl2 sc1
    s_cmp_ge_u32 s37, 200000
    s_cbranch_scc1 L_got_80
L_poll_78:
    buffer_load_dword v16, v32, s[16:19], s40 offen sc1
L_poll_78w:
    s_waitcnt vmcnt(0)
L_chk_79:
    v_cmp_eq_u32 vcc, -1, v16
    s_cbranch_vccnz L_again_77
L_got_80:
    s_mov_b32 s37, 0
L_aw_81:
    buffer_load_dword v16, v116, s[16:19], s59 offen sc1
    s_waitcnt vmcnt(0)
    v_cmp_o_f32 vcc, v16, v16
    s_cbranch_vccnz L_awd_82
    s_sleep 2
    s_add_u32 s37, s37, 1
    s_cmp_lt_u32 s37, 64
    s_cbranch_scc1 L_aw_81
L_awd_82:
    s_mov_b32 s37, 0
    s_branch L_poll_84
L_again_83:
    s_add_u32 s37, s37, 1
    s_and_b32 s45, s37, 255
    s_cbranch_scc1 L_poll_84
    buffer_wbl2 sc1
    s_cmp_ge_u32 s37, 200000
    s_cbranch_scc1 L_got_86
L_poll_84:
    buffer_load_dwordx4 v[16:19], v116, s[16:19], s59 offen offset:0 sc1
    buffer_load_dwordx4 v[20:23], v116, s[16:19], s59 offen offset:1024 sc1
    buffer_load_dwordx4 v[24:27], v116, s[16:19], s59 offen offset:2048 sc1
    buffer_load_dwordx4 v[28:31], v116, s[16:19], s59 offen offset:3072 sc1
L_poll_84w:
    s_waitcnt vmcnt(0)
L_chk_85:
    v_add_f32 v16, v16, v20
    v_add_f32 v24, v24, v28
    v_add_f32 v17, v17, v21
    v_add_f32 v25, v25, v29
    v_add_f32 v18, v18, v22
    v_add_f32 v26, v26, v30
    v_add_f32 v19, v19, v23
    v_add_f32 v27, v27, v31
    v_add_f32 v16, v16, v24
    v_add_f32 v17, v17, v25
    v_add_f32 v18, v18, v26
    v_add_f32 v19, v19, v27
    v_permlane32_swap_b32 v16, v17
    s_nop 0
    v_permlane32_swap_b32 v18, v19
    v_add_f32 v16, v16, v17
    v_add_f32 v18, v18, v19
    s_nop 1
    v_permlane16_swap_b32 v16, v18
    v_add_f32 v16, v16, v18
    v_cmp_u_f32 vcc, v16, v16
    s_cbranch_vccnz L_again_83
L_got_86:
    v_add_f32_dpp v16, v16, v16 row_ror:8 row_mask:0xf bank_mask:0xf
    s_nop 1
    v_add_f32_dpp v16, v16, v16 row_ror:4 row_mask:0xf bank_mask:0xf
    s_nop 1
    v_add_f32_dpp v16, v16, v16 row_ror:2 row_mask:0xf bank_mask:0xf
    s_waitcnt lgkmcnt(0)
    s_mov_b32 exec_lo, 0x30003
    s_mov_b32 exec_hi, 0x30003
    v_fma_f32 v16, v16, v74, v42
    v_cvt_pk_bf16_f32 v16, v16, v16
    buffer_store_short v16, v114, s[32:35], s62 offen
    s_cmp_lg_u32 s2, 128
    s_cbranch_scc1 L_exit
    s_sub_u32 s40, s36, 0x9e3779b8
    v_mov_b32 v17, s40
    v_mov_b32 v18, 0
    s_mov_b64 exec, 1
    buffer_store_dword v17, v18, s[16:19], 0 offen sc1
    s_branch L_exit
L_c_2:
    s_lshr_b32 s3, s3, 6
    s_bfe_u32 s5, s2, 0x40003
    s_lshl1_add_u32 s58, s4, s6
    s_mov_b32 s18, 8388608
    s_mov_b32 s19, s11
    s_lshl_b32 s63, s4, 4
    s_add_u32 s63, s63, s5
    s_lshl_b32 s96, s63, 10
    s_add_u32 s96, s96, 0x100000
    s_lshl_b32 s98, s4, 7
    s_add_u32 s98, s98, 0x60000
    v_lshlrev_b32 v122, 4, v0
    v_lshlrev_b32 v148, 7, v0
    s_movk_i32 s99, 16384
    s_load_dwordx2 s[20:21], s[0:1], 48
    s_load_dwordx2 s[12:13], s[0:1], 56
    s_load_dwordx2 s[28:29], s[0:1], 64
    v_mul_u32_u24 v124, 3584, v7
    v_add_u32 v124, v124, v8
    v_lshl_or_b32 v125, v7, 10, v8
    s_mov_b32 s22, 1835008
    s_mov_b32 s23, s11
    s_mov_b32 s14, 1835008
    s_mov_b32 s15, s11
    s_mov_b32 s30, 1835008
    s_mov_b32 s31, s11
    s_and_b32 s49, s63, 3
    s_lshl_b32 s49, s49, 7
    s_lshl4_add_u32 s49, s3, s49
    s_mul_i32 s49, s49, 3584
    s_lshr_b32 s50, s63, 2
    s_lshl_b32 s50, s50, 7
    s_add_u32 s49, s49, s50
    s_add_u32 s50, s49, 27648
    s_lshl_b32 s51, s63, 14
    s_lshl_b32 s45, s3, 7
    s_add_u32 s51, s51, s45
    s_add_u32 s52, s51, 7168
    s_lshl_b32 s42, s3, 11
    s_lshl_b32 s44, s58, 12
    s_lshl_b32 s45, s3, 10
    s_add_u32 s44, s44, s45
    s_add_u32 s44, s44, 0x10000
    v_and_b32 v123, 7, v0
    v_lshlrev_b32 v123, 7, v123
    v_bfe_u32 v9, v0, 3, 1
    v_lshl_or_b32 v123, v9, 6, v123
    v_lshl_or_b32 v123, v1, 4, v123
    s_and_b32 s59, s63, 3
    s_lshl_b32 s59, s59, 13
    s_and_b32 s45, s3, 3
    s_lshl_b32 s45, s45, 11
    s_add_u32 s59, s59, s45
    s_add_u32 s59, s59, 0x30000
    s_lshr_b32 s40, s3, 2
    s_lshl_b32 s40, s40, 15
    s_sub_u32 s59, s59, s40
    v_and_b32 v9, 7, v0
    v_lshlrev_b32 v9, 1, v9
    v_xor_b32 v9, v1, v9
    v_lshlrev_b32 v9, 4, v9
    v_lshl_or_b32 v9, v2, 8, v9
    v_add_u32 v108, s43, v9
    v_xor_b32 v109, 0x40, v108
    v_xor_b32 v110, 0x80, v108
    v_xor_b32 v111, 0xc0, v108
    s_lshl_b32 s40, s3, 5
    s_add_u32 s40, s40, 0x24400
    v_bfe_u32 v3, v0, 1, 4
    v_lshlrev_b32 v3, 7, v3
    v_lshrrev_b32 v9, 5, v0
    v_lshl_or_b32 v3, v9, 4, v3
    v_and_b32 v9, 1, v0
    v_lshl_or_b32 v3, v9, 3, v3
    v_add_u32 v3, s40, v3
    v_lshlrev_b32 v4, 7, v1
    v_and_b32 v9, 7, v0
    v_lshl_or_b32 v4, v9, 4, v4
    v_add_u32 v4, 148480, v4
    v_bfe_u32 v7, v0, 2, 3
    v_xor_b32 v7, s3, v7
    v_lshrrev_b32 v5, 2, v0
    v_lshlrev_b32 v5, 8, v5
    v_and_b32 v9, 3, v0
    v_lshl_or_b32 v5, v9, 3, v5
    v_add_u32 v5, 65536, v5
    v_lshl_or_b32 v5, v7, 5, v5
    v_and_b32 v6, 3, v0
    v_lshlrev_b32 v6, 5, v6
    v_add_u32 v6, 152576, v6
    s_lshl_b32 s40, s3, 2
    v_add_u32 v112, s40, v6
    v_lshlrev_b32 v13, 6, v1
    v_and_b32 v9, 3, v0
    v_lshl_or_b32 v13, v9, 4, v13
    v_add_u32 v13, 150528, v13
    s_lshl_b32 s40, s3, 8
    v_and_b32 v9, 12, v0
    v_add3_u32 v113, s40, v13, v9
    s_mov_b32 s60, 0xf0f0f0f0
    s_mov_b32 s61, s60
    s_mov_b32 s46, 0xff00ff00
    s_mov_b32 s47, s46
    v_and_b32 v116, 3, v0
    v_lshlrev_b32 v116, 13, v116
    v_lshl_or_b32 v116, v1, 4, v116
    s_lshl_b32 s53, s4, 15
    s_lshl_b32 s45, s3, 10
    s_add_u32 s53, s53, s45
    s_lshl_b32 s45, s5, 6
    s_add_u32 s53, s53, s45
    s_add_u32 s53, s53, 0x80000
    v_and_b32 v117, 3, v0
    v_lshlrev_b32 v117, 8, v117
    s_lshl_b32 s54, s4, 10
    s_lshl4_add_u32 s54, s5, s54
    s_add_u32 s54, s54, 0x2000
    s_mov_b32 s55, 0x3e0293ee
    s_waitcnt vmcnt(7) lgkmcnt(0)
    s_add_u32 s36, s36, 0x9e3779b9
    ds_read_b128 v[16:19], v108 offset:0
    ds_read_b128 v[20:23], v109 offset:0
    ds_read_b128 v[24:27], v110 offset:0
    ds_read_b128 v[28:31], v111 offset:0
    ds_read_b128 v[32:35], v108 offset:4096
    ds_read_b128 v[36:39], v109 offset:4096
    ds_read_b128 v[40:43], v110 offset:4096
    ds_read_b128 v[44:47], v111 offset:4096
    v_mov_b32 v105, s36
    v_mov_b32 v107, s36
    v_mov_b32 v145, s36
    v_mov_b32 v147, s36
    s_cmp_lg_u32 s3, 5
    s_cbranch_scc1 L_npt_3
    s_mov_b64 exec, 1
    buffer_load_dword v137, v0, s[20:23], s49 offen
    buffer_load_dword v137, v0, s[12:15], s49 offen
    buffer_load_dword v137, v0, s[28:31], s51 offen
    s_mov_b64 exec, -1
L_npt_3:
    v_lshlrev_b32 v150, 2, v2
    s_movk_i32 s101, 6144
    s_cmp_ge_u32 s3, 4
    s_cbranch_scc1 L_nqp_4
    s_mov_b32 s37, 0
    s_branch L_poll_6
L_again_5:
    s_sleep 1
    s_add_u32 s37, s37, 1
    s_and_b32 s45, s37, 255
    s_cbranch_scc1 L_poll_6
    buffer_wbl2 sc1
    s_cmp_ge_u32 s37, 200000
    s_cbranch_scc1 L_got_8
L_poll_6:
    buffer_load_dwordx4 v[100:103], v122, s[16:19], s44 offen sc1
L_poll_6w:
    s_waitcnt vmcnt(0)
L_chk_7:
    v_xor_b32 v7, s36, v101
    v_bitop3_b32 v7, v103, s36, v7 bitop3:0xbe
    v_cmp_ne_u32 vcc, 0, v7
    s_cbranch_vccnz L_again_5
L_got_8:
    v_mov_b32 v101, v102
    ds_write_b64 v3, v[100:101]
L_nqp_4:
    s_waitcnt vmcnt(0) lgkmcnt(0)
    s_barrier
    ds_read_b128 v[80:83], v4 offset:0
    ds_read_b128 v[84:87], v4 offset:512
    ds_read_b128 v[88:91], v4 offset:1024
    ds_read_b128 v[92:95], v4 offset:1536
    s_waitcnt lgkmcnt(3)
    v_mfma_f32_16x16x32_bf16 v[96:99], v[16:19], v[80:83], 0
    v_mfma_f32_16x16x32_bf16 v[100:103], v[32:35], v[80:83], 0
    s_waitcnt lgkmcnt(2)
    v_mfma_f32_16x16x32_bf16 v[96:99], v[20:23], v[84:87], v[96:99]
    v_mfma_f32_16x16x32_bf16 v[100:103], v[36:39], v[84:87], v[100:103]
    s_waitcnt lgkmcnt(1)
    v_mfma_f32_16x16x32_bf16 v[96:99], v[24:27], v[88:91], v[96:99]
    v_mfma_f32_16x16x32_bf16 v[100:103], v[40:43], v[88:91], v[100:103]
    s_waitcnt lgkmcnt(0)
    v_mfma_f32_16x16x32_bf16 v[96:99], v[28:31], v[92:95], v[96:99]
    v_mfma_f32_16x16x32_bf16 v[100:103], v[44:47], v[92:95], v[100:103]
    ds_read_b64_tr_b16 v[48:49], v5 offset:0
    ds_read_b64_tr_b16 v[50:51], v5 offset:4096
    ds_read_b64_tr_b16 v[52:53], v5 offset:8192
    ds_read_b64_tr_b16 v[54:55], v5 offset:12288
    ds_read_b64_tr_b16 v[56:57], v5 offset:16384
    ds_read_b64_tr_b16 v[58:59], v5 offset:20480
    buffer_load_dwordx4 v[128:131], v123, s[16:19], s59 offen sc1
    buffer_load_dwordx4 v[132:135], v123, s[16:19], s59 offen offset:1024 sc1
    buffer_load_dword v151, v150, s[16:19], s101 offen sc1
    v_add_f32_dpp v96, v96, v96 row_ror:4 row_mask:0xf bank_mask:0xf
    v_add_f32_dpp v97, v97, v97 row_ror:4 row_mask:0xf bank_mask:0xf
    v_add_f32_dpp v98, v98, v98 row_ror:4 row_mask:0xf bank_mask:0xf
    v_add_f32_dpp v99, v99, v99 row_ror:4 row_mask:0xf bank_mask:0xf
    v_add_f32_dpp v100, v100, v100 row_ror:4 row_mask:0xf bank_mask:0xf
    v_add_f32_dpp v101, v101, v101 row_ror:4 row_mask:0xf bank_mask:0xf
    v_add_f32_dpp v102, v102, v102 row_ror:4 row_mask:0xf bank_mask:0xf
    v_add_f32_dpp v103, v103, v103 row_ror:4 row_mask:0xf bank_mask:0xf
    v_max3_f32 v7, v96, v97, v98
    v_max3_f32 v9, v99, v100, v101
    v_max3_f32 v7, v7, v102, v103
    v_max_f32 v10, v7, v9
    v_max_f32 v7, v7, v9
    v_cndmask_b32 v96, v96, v98, s[60:61]
    v_cndmask_b32 v97, v97, v99, s[60:61]
    v_permlane32_swap_b32 v7, v10
    v_max_f32 v9, v7, v10
    v_max_f32 v7, v7, v10
    v_cndmask_b32 v100, v100, v102, s[60:61]
    v_cndmask_b32 v101, v101, v103, s[60:61]
    v_permlane16_swap_b32 v7, v9
    v_max_f32 v7, v7, v9
    ds_write_b32 v112, v7
    v_cndmask_b32 v96, v96, v100, s[46:47]
    v_cndmask_b32 v97, v97, v101, s[46:47]
    v_mul_f32 v96, s55, v96
    v_mul_f32 v97, s55, v97
    s_cmp_lg_u32 s3, 7
    s_cbranch_scc1 L_nlt_9
    buffer_load_dwordx4 v[136:139], v122, s[16:19], s96 offen sc1
    buffer_load_dword v136, v125, s[16:19], s98 offen sc1
    buffer_load_dwordx4 v[140:143], v148, s[16:19], s99 offen sc1
L_nlt_9:
    s_waitcnt lgkmcnt(0)
    s_barrier
    ds_read_b128 v[80:83], v6
    ds_read_b128 v[84:87], v6 offset:16
    ds_read_b64_tr_b16 v[60:61], v5 offset:24576
    ds_read_b64_tr_b16 v[62:63], v5 offset:28672
    ds_read_b64_tr_b16 v[64:65], v5 offset:32768
    ds_read_b64_tr_b16 v[66:67], v5 offset:36864
    ds_read_b64_tr_b16 v[68:69], v5 offset:40960
    ds_read_b64_tr_b16 v[70:71], v5 offset:45056
    ds_read_b64_tr_b16 v[72:73], v5 offset:49152
    ds_read_b64_tr_b16 v[74:75], v5 offset:53248
    ds_read_b64_tr_b16 v[76:77], v5 offset:57344
    ds_read_b64_tr_b16 v[78:79], v5 offset:61440
    s_waitcnt lgkmcnt(10)
    v_max3_f32 v7, v80, v81, v82
    v_max3_f32 v9, v83, v84, v85
    v_max3_f32 v7, v7, v86, v87
    v_max_f32 v7, v7, v9
    v_fma_f32 v96, -v7, s55, v96
    v_fma_f32 v97, -v7, s55, v97
    v_exp_f32 v96, v96
    v_exp_f32 v97, v97
    v_mul_f32 v144, s55, v7
    v_cvt_pk_bf16_f32 v8, v96, v97
    v_add_f32 v7, v96, v97
    ds_write_b32 v113, v8
    s_nop 0
    v_add_f32_dpp v7, v7, v7 row_ror:4 row_mask:0xf bank_mask:0xf
    s_nop 1
    v_add_f32_dpp v10, v7, v7 row_ror:8 row_mask:0xf bank_mask:0xf
    v_add_f32_dpp v7, v7, v7 row_ror:8 row_mask:0xf bank_mask:0xf
    s_nop 1
    v_permlane32_swap_b32 v7, v10
    v_add_f32 v9, v7, v10
    v_add_f32 v7, v7, v10
    s_nop 1
    v_permlane16_swap_b32 v7, v9
    v_add_f32 v7, v7, v9
    ds_write_b32 v112, v7 offset:128
    s_waitcnt lgkmcnt(0)
    s_barrier
    s_cmp_lg_u32 s3, 0
    s_cbranch_scc1 L_nst_10
    ds_read_b128 v[80:83], v6 offset:128
    ds_read_b128 v[84:87], v6 offset:144
L_nst_10:
    ds_read_b128 v[16:19], v13 offset:0
    ds_read_b128 v[20:23], v13 offset:256
    ds_read_b128 v[24:27], v13 offset:512
    ds_read_b128 v[28:31], v13 offset:768
    ds_read_b128 v[32:35], v13 offset:1024
    ds_read_b128 v[36:39], v13 offset:1280
    ds_read_b128 v[40:43], v13 offset:1536
    ds_read_b128 v[44:47], v13 offset:1792
    s_cbranch_scc1 L_nsu_11
    s_waitcnt lgkmcnt(8)
    v_add_f32 v80, v80, v81
    v_add_f32 v82, v82, v83
    v_add_f32 v84, v84, v85
    v_add_f32 v86, v86, v87
    v_add_f32 v80, v80, v82
    v_add_f32 v84, v84, v86
    v_add_f32 v146, v80, v84
    s_mov_b64 exec, 15
    buffer_store_dwordx4 v[144:147], v117, s[16:19], s54 offen
    s_mov_b64 exec, -1
L_nsu_11:
    s_waitcnt lgkmcnt(7)
    v_mfma_f32_16x16x32_bf16 v[108:111], v[48:51], v[16:19], 0
    s_waitcnt lgkmcnt(6)
    v_mfma_f32_16x16x32_bf16 v[108:111], v[52:55], v[20:23], v[108:111]
    s_waitcnt lgkmcnt(5)
    v_mfma_f32_16x16x32_bf16 v[108:111], v[56:59], v[24:27], v[108:111]
    s_waitcnt lgkmcnt(4)
    v_mfma_f32_16x16x32_bf16 v[108:111], v[60:63], v[28:31], v[108:111]
    s_waitcnt lgkmcnt(3)
    v_mfma_f32_16x16x32_bf16 v[108:111], v[64:67], v[32:35], v[108:111]
    s_waitcnt lgkmcnt(2)
    v_mfma_f32_16x16x32_bf16 v[108:111], v[68:71], v[36:39], v[108:111]
    s_waitcnt lgkmcnt(1)
    v_mfma_f32_16x16x32_bf16 v[108:111], v[72:75], v[40:43], v[108:111]
    s_waitcnt lgkmcnt(0)
    v_mfma_f32_16x16x32_bf16 v[108:111], v[76:79], v[44:47], v[108:111]
    s_mov_b32 exec_lo, 0xf000f
    s_mov_b32 exec_hi, 0xf000f
    s_add_u32 m0, s42, 0
    s_nop 4
    v_cvt_pk_bf16_f32 v104, v108, v109
    v_cvt_pk_bf16_f32 v106, v110, v111
    buffer_store_dwordx4 v[104:107], v116, s[16:19], s53 offen
    s_mov_b64 exec, -1
    s_cmp_eq_u32 s4, 7
    s_cbranch_scc1 L_g7
    s_barrier
    buffer_load_dwordx4 v124, s[20:23], s49 offen nt lds
    buffer_load_dwordx4 v124, s[20:23], s50 offen offset:1024 nt lds
    s_add_u32 m0, s42, 16384
    s_nop 0
    buffer_load_dwordx4 v124, s[12:15], s49 offen nt lds
    buffer_load_dwordx4 v124, s[12:15], s50 offen offset:1024 nt lds
    s_barrier
    s_add_u32 m0, s42, 32768
    s_nop 0
    buffer_load_dwordx4 v125, s[28:31], s51 offen nt lds
    buffer_load_dwordx4 v125, s[28:31], s52 offen offset:1024 nt lds
    v_lshrrev_b32 v6, 2, v0
    v_lshlrev_b32 v6, 7, v6
    v_bfe_u32 v32, v0, 3, 2
    v_lshl_or_b32 v6, v32, 5, v6
    v_and_b32 v32, 3, v0
    v_lshl_or_b32 v6, v32, 3, v6
    s_and_b32 s40, s3, 3
    s_lshl_b32 s40, s40, 5
    v_xor_b32 v115, s40, v6
    s_lshr_b32 s40, s3, 2
    s_lshl_b32 s40, s40, 14
    v_add_u32 v115, s40, v115
    s_add_u32 s40, s42, 32768
    v_add_u32 v108, s40, v6
    v_xor_b32 v109, 0x20, v108
    v_xor_b32 v110, 0x40, v108
    v_xor_b32 v111, 0x60, v108
    v_add_u32 v114, 131072, v122
    s_lshl_b32 s40, s3, 10
    v_add_u32 v113, s40, v114
    v_lshlrev_b32 v116, 2, v0
    s_lshr_b32 s61, s63, 2
    s_lshl_b32 s61, s61, 12
    s_and_b32 s45, s3, 3
    s_lshl_b32 s45, s45, 10
    s_add_u32 s61, s61, s45
    s_and_b32 s45, s5, 3
    s_lshl_b32 s45, s45, 8
    s_add_u32 s61, s61, s45
    s_lshr_b32 s45, s3, 2
    s_lshl_b32 s45, s45, 7
    s_add_u32 s61, s61, s45
    s_add_u32 s61, s61, 0xfffc0
    v_bfe_u32 v118, v0, 2, 1
    v_lshlrev_b32 v118, 7, v118
    v_bfe_u32 v32, v0, 3, 1
    v_lshl_or_b32 v118, v32, 6, v118
    v_lshl_or_b32 v118, v1, 4, v118
    v_and_b32 v32, 3, v0
    v_lshl_or_b32 v118, v32, 2, v118
    v_and_b32 v119, 3, v0
    v_lshlrev_b32 v119, 5, v119
    v_bfe_u32 v32, v0, 2, 1
    v_lshl_or_b32 v119, v32, 10, v119
    v_lshrrev_b32 v32, 5, v0
    v_lshl_or_b32 v119, v32, 4, v119
    v_bfe_u32 v120, v0, 3, 1
    v_lshlrev_b32 v120, 13, v120
    v_lshrrev_b32 v32, 5, v0
    v_lshl_or_b32 v120, v32, 12, v120
    v_bfe_u32 v32, v0, 4, 1
    v_lshl_or_b32 v120, v32, 4, v120
    s_lshr_b32 s47, s3, 2
    s_lshl_b32 s47, s47, 15
    s_bfe_u32 s45, s5, 0x10001
    s_lshl_b32 s45, s45, 14
    s_add_u32 s47, s47, s45
    s_and_b32 s45, s5, 1
    s_lshl_b32 s45, s45, 12
    s_add_u32 s47, s47, s45
    s_and_b32 s45, s3, 3
    s_lshl_b32 s45, s45, 10
    s_add_u32 s47, s47, s45
    s_add_u32 s47, s47, 0x50000
    s_lshl_b32 s49, s3, 16
    s_lshl_b32 s45, s63, 5
    s_add_u32 s49, s49, s45
    s_add_u32 s49, s49, 0x180000
    s_add_u32 s50, s49, 16384
    s_add_u32 s51, s49, 32768
    s_add_u32 s52, s49, 49152
    s_mov_b32 s41, 0x3b000000
    s_mov_b32 s43, 0x3727c5ac
    s_mov_b32 s37, 0
    s_waitcnt vmcnt(6)
    s_branch L_chk_14
L_again_12:
    s_sleep 4
    s_add_u32 s37, s37, 1
    s_and_b32 s45, s37, 255
    s_cbranch_scc1 L_poll_13
    buffer_wbl2 sc1
    s_cmp_ge_u32 s37, 200000
    s_cbranch_scc1 L_got_15
L_poll_13:
    buffer_load_dwordx4 v[128:131], v123, s[16:19], s59 offen sc1
    buffer_load_dwordx4 v[132:135], v123, s[16:19], s59 offen offset:1024 sc1
L_poll_13w:
    s_waitcnt vmcnt(0)
L_chk_14:
    v_xor_b32 v33, s36, v129
    v_bitop3_b32 v33, v131, s36, v33 bitop3:0xbe
    v_bitop3_b32 v33, v133, s36, v33 bitop3:0xbe
    v_bitop3_b32 v33, v135, s36, v33 bitop3:0xbe
    v_cmp_ne_u32 vcc, 0, v33
    s_cbranch_vccnz L_again_12
L_got_15:
    v_mov_b32 v129, v130
    v_mov_b32 v130, v132
    v_mov_b32 v131, v134
    s_xor_b32 s40, s36, 0x80000000
    v_cmp_eq_u32 vcc, s40, v151
    s_bcnt1_i32_b32 s45, vcc_lo
    v_cmp_eq_u32 vcc, s36, v151
    s_bcnt1_i32_b32 s40, vcc_lo
    s_cmp_gt_u32 s45, s40
    s_cselect_b32 s40, 4, 0
    s_xor_b32 s40, s40, s2
    s_and_b32 s40, s40, 4
    s_lshl_b32 s40, s40, 11
    s_add_u32 s47, s47, s40
    ds_write_b128 v113, v[128:131]
    s_cmp_lg_u32 s3, 7
    s_cbranch_scc1 L_ntk_16
    s_mov_b32 s37, 0
    s_waitcnt vmcnt(6)
    s_branch L_chk_19
L_again_17:
    s_sleep 2
    s_add_u32 s37, s37, 1
    s_and_b32 s45, s37, 255
    s_cbranch_scc1 L_poll_18
    buffer_wbl2 sc1
    s_cmp_ge_u32 s37, 200000
    s_cbranch_scc1 L_got_20
L_poll_18:
    buffer_load_dwordx4 v[140:143], v148, s[16:19], s99 offen sc1
L_poll_18w:
    s_waitcnt vmcnt(0)
L_chk_19:
    v_xor_b32 v33, s36, v140
    v_bitop3_b32 v33, v141, s36, v33 bitop3:0xbe
    v_bitop3_b32 v33, v142, s36, v33 bitop3:0xbe
    v_bitop3_b32 v33, v143, s36, v33 bitop3:0xbe
    v_cmp_ne_u32 vcc, 0, v33
    s_cbranch_vccnz L_again_17
L_got_20:
L_ntk_16:
    s_waitcnt vmcnt(2) lgkmcnt(0)
    s_barrier
    buffer_load_dwordx4 v[76:79], v123, s[16:19], s47 offen sc1
    ds_read_b64_tr_b16 v[84:85], v115 offset:0
    ds_read_b64_tr_b16 v[86:87], v115 offset:2048
    ds_read_b64_tr_b16 v[88:89], v115 offset:4096
    ds_read_b64_tr_b16 v[90:91], v115 offset:6144
    ds_read_b64_tr_b16 v[92:93], v115 offset:8192
    ds_read_b64_tr_b16 v[94:95], v115 offset:10240
    ds_read_b64_tr_b16 v[96:97], v115 offset:12288
    ds_read_b64_tr_b16 v[98:99], v115 offset:14336
    ds_read_b128 v[16:19], v114 offset:0
    ds_read_b128 v[20:23], v114 offset:1024
    ds_read_b128 v[24:27], v114 offset:2048
    ds_read_b128 v[28:31], v114 offset:3072
    ds_read_b128 v[32:35], v114 offset:4096
    ds_read_b128 v[36:39], v114 offset:5120
    ds_read_b128 v[100:103], v114 offset:6144
    ds_read_b128 v[104:107], v114 offset:7168
    s_waitcnt lgkmcnt(0)
    v_mfma_f32_16x16x32_bf16 v[56:59], v[16:19], v[84:87], 0
    v_mfma_f32_16x16x32_bf16 v[60:63], v[32:35], v[84:87], 0
    v_mfma_f32_16x16x32_bf16 v[56:59], v[20:23], v[88:91], v[56:59]
    v_mfma_f32_16x16x32_bf16 v[60:63], v[36:39], v[88:91], v[60:63]
    v_mfma_f32_16x16x32_bf16 v[56:59], v[24:27], v[92:95], v[56:59]
    v_mfma_f32_16x16x32_bf16 v[60:63], v[100:103], v[92:95], v[60:63]
    v_mfma_f32_16x16x32_bf16 v[56:59], v[28:31], v[96:99], v[56:59]
    v_mfma_f32_16x16x32_bf16 v[60:63], v[104:107], v[96:99], v[60:63]
    s_nop 6
    v_add_f32 v56, v56, v57
    v_add_f32 v58, v58, v59
    v_add_f32 v60, v60, v61
    v_add_f32 v62, v62, v63
    v_add_f32 v56, v56, v58
    v_add_f32 v60, v60, v62
    s_nop 1
    v_permlane16_swap_b32 v56, v60
    v_add_f32 v121, v56, v60
    v_add_f32 v117, v56, v60
    v_mov_b32 v146, s43
    s_nop 0
    v_permlane16_swap_b32 v121, v117
    s_mov_b32 s37, 0
    s_branch L_poll_22w
L_again_21:
    s_add_u32 s37, s37, 1
    s_and_b32 s45, s37, 255
    s_cbranch_scc1 L_poll_22
    buffer_wbl2 sc1
    s_cmp_ge_u32 s37, 200000
    s_cbranch_scc1 L_got_24
L_poll_22:
    buffer_load_dwordx4 v[76:79], v123, s[16:19], s47 offen sc1
L_poll_22w:
    s_waitcnt vmcnt(0)
L_chk_23:
    v_max3_u32 v33, v76, v77, v78
    v_max_u32 v33, v33, v79
    v_cmp_eq_u32 vcc, -1, v33
    s_cbranch_vccnz L_again_21
L_got_24:
    ds_write_b128 v113, v[76:79] offset:8192
    s_waitcnt lgkmcnt(0)
    s_barrier
    ds_read_b128 v[16:19], v114 offset:8192
    ds_read_b128 v[20:23], v114 offset:9216
    ds_read_b128 v[24:27], v114 offset:10240
    ds_read_b128 v[28:31], v114 offset:11264
    ds_read_b128 v[32:35], v114 offset:12288
    ds_read_b128 v[36:39], v114 offset:13312
    ds_read_b128 v[100:103], v114 offset:14336
    ds_read_b128 v[104:107], v114 offset:15360
    buffer_load_dwordx4 v[40:43], v119, s[16:19], s98 offen sc1
    s_waitcnt lgkmcnt(7)
    v_mfma_f32_16x16x32_bf16 v[56:59], v[16:19], v[84:87], 0
    s_waitcnt lgkmcnt(6)
    v_mfma_f32_16x16x32_bf16 v[56:59], v[20:23], v[88:91], v[56:59]
    s_waitcnt lgkmcnt(5)
    v_mfma_f32_16x16x32_bf16 v[56:59], v[24:27], v[92:95], v[56:59]
    s_waitcnt lgkmcnt(4)
    v_mfma_f32_16x16x32_bf16 v[56:59], v[28:31], v[96:99], v[56:59]
    s_waitcnt lgkmcnt(3)
    v_mfma_f32_16x16x32_bf16 v[56:59], v[32:35], v[84:87], v[56:59]
    s_waitcnt lgkmcnt(2)
    v_mfma_f32_16x16x32_bf16 v[56:59], v[36:39], v[88:91], v[56:59]
    s_waitcnt lgkmcnt(1)
    v_mfma_f32_16x16x32_bf16 v[56:59], v[100:103], v[92:95], v[56:59]
    s_waitcnt lgkmcnt(0)
    v_mfma_f32_16x16x32_bf16 v[56:59], v[104:107], v[96:99], v[56:59]
    ds_read_b64_tr_b16 v[64:65], v108
    ds_read_b64_tr_b16 v[66:67], v109
    ds_read_b64_tr_b16 v[68:69], v110
    ds_read_b64_tr_b16 v[70:71], v111
    s_mov_b32 s37, 0
    s_branch L_poll_26w
L_again_25:
    s_add_u32 s37, s37, 1
    s_and_b32 s45, s37, 255
    s_cbranch_scc1 L_poll_26
    buffer_wbl2 sc1
    s_cmp_ge_u32 s37, 200000
    s_cbranch_scc1 L_got_28
L_poll_26:
    buffer_load_dwordx4 v[40:43], v119, s[16:19], s98 offen sc1
L_poll_26w:
    s_waitcnt vmcnt(0)
L_chk_27:
    v_add_f32 v40, v40, v42
    v_add_f32 v41, v41, v43
    v_cmp_u_f32 vcc, v40, v41
    s_cbranch_vccnz L_again_25
L_got_28:
    v_add_f32_dpp v40, v40, v40 quad_perm:[1,0,3,2] row_mask:0xf bank_mask:0xf
    v_add_f32_dpp v41, v41, v41 quad_perm:[1,0,3,2] row_mask:0xf bank_mask:0xf
    v_add_f32 v56, v56, v57
    v_add_f32 v58, v58, v59
    v_add_f32_dpp v40, v40, v40 quad_perm:[2,3,0,1] row_mask:0xf bank_mask:0xf
    v_add_f32_dpp v41, v41, v41 quad_perm:[2,3,0,1] row_mask:0xf bank_mask:0xf
    v_add_f32 v57, v56, v58
    v_add_f32 v56, v56, v58
    v_add_f32_dpp v40, v40, v40 row_half_mirror row_mask:0xf bank_mask:0xf
    v_add_f32_dpp v41, v41, v41 row_half_mirror row_mask:0xf bank_mask:0xf
    v_permlane16_swap_b32 v56, v57
    v_mul_f32 v40, s41, v40
    v_fma_f32 v41, v41, s41, v146
    v_add_f32 v56, v56, v57
    v_fma_f32 v41, -v40, v40, v41
    v_fma_f32 v56, -v40, v121, v56
    v_rsq_f32 v41, v41
    s_mov_b32 exec_lo, 0xffff0000
    s_mov_b32 exec_hi, 0xffff
    v_fma_f32 v144, v56, v41, v117
    buffer_store_dword v144, v116, s[16:19], s61 offen
    s_mov_b64 exec, -1
    s_mov_b32 s37, 0
    s_branch L_poll_30
L_again_29:
    s_add_u32 s37, s37, 1
    s_and_b32 s45, s37, 255
    s_cbranch_scc1 L_poll_30
    buffer_wbl2 sc1
    s_cmp_ge_u32 s37, 200000
    s_cbranch_scc1 L_got_32
L_poll_30:
    buffer_load_dword v20, v118, s[16:19], s96 offen offset:0 sc1
    buffer_load_dword v21, v118, s[16:19], s96 offen offset:256 sc1
    buffer_load_dword v22, v118, s[16:19], s96 offen offset:512 sc1
    buffer_load_dword v23, v118, s[16:19], s96 offen offset:768 sc1
L_poll_30w:
    s_waitcnt vmcnt(0)
L_chk_31:
    v_add_f32 v20, v20, v21
    v_add_f32 v22, v22, v23
    v_add_f32 v20, v20, v22
    v_cmp_u_f32 vcc, v20, v20
    s_cbranch_vccnz L_again_29
L_got_32:
    v_max_f32 v21, 0, v20
    s_nop 1
    v_mul_f32_dpp v22, v20, v21 row_shl:4 row_mask:0xf bank_mask:0xf
    s_nop 1
    v_mov_b32_dpp v23, v22 quad_perm:[1,1,3,3] row_mask:0xf bank_mask:0xf
    v_cvt_pk_bf16_f32 v24, v22, v23
    s_nop 1
    v_mov_b32_dpp v25, v24 quad_perm:[2,2,2,2] row_mask:0xf bank_mask:0xf
    s_waitcnt lgkmcnt(0)
    s_nop 0
    v_mfma_f32_16x16x16_bf16 v[32:35], v[64:65], v[24:25], 0
    v_mfma_f32_16x16x16_bf16 v[36:39], v[66:67], v[24:25], 0
    v_mfma_f32_16x16x16_bf16 v[40:43], v[68:69], v[24:25], 0
    v_mfma_f32_16x16x16_bf16 v[44:47], v[70:71], v[24:25], 0
    s_mov_b32 exec_lo, 0x1010101
    s_mov_b32 exec_hi, 0x1010101
    s_nop 2
    buffer_store_dwordx4 v[32:35], v120, s[16:19], s49 offen sc1
    buffer_store_dwordx4 v[36:39], v120, s[16:19], s50 offen sc1
    buffer_store_dwordx4 v[40:43], v120, s[16:19], s51 offen sc1
    buffer_store_dwordx4 v[44:47], v120, s[16:19], s52 offen sc1
    s_waitcnt vmcnt(0)
    s_mov_b32 exec_lo, 0xffff0000
    s_mov_b32 exec_hi, 0xffff
    buffer_store_dword v144, v116, s[16:19], s61 offen sc1
    s_branch L_exit
L_g7:
    s_cmp_lg_u32 s3, 0
    s_cbranch_scc1 L_exit
    v_bfe_u32 v8, v0, 3, 1
    v_lshlrev_b32 v8, 15, v8
    v_bfe_u32 v9, v0, 2, 1
    v_lshl_or_b32 v8, v9, 14, v8
    v_and_b32 v9, 3, v0
    v_lshl_or_b32 v8, v9, 11, v8
    s_mov_b32 s46, 0x40380
    s_mov_b32 s37, 0
    s_branch L_poll_34
L_again_33:
    s_sleep 8
    s_add_u32 s37, s37, 1
    s_and_b32 s45, s37, 255
    s_cbranch_scc1 L_poll_34
    buffer_wbl2 sc1
    s_cmp_ge_u32 s37, 200000
    s_cbranch_scc1 L_got_36
L_poll_34:
    buffer_load_dword v16, v8, s[16:19], s46 offen sc1
L_poll_34w:
    s_waitcnt vmcnt(0)
L_chk_35:
    v_cmp_eq_u32 vcc, -1, v16
    s_cbranch_vccnz L_again_33
L_got_36:
    s_branch L_exit
L_exit:
L_end:
    s_endpgm
L_codeend:
.fill (16384 - (L_codeend - adaLN_cond__sliding_block_cached__glu_gated_reglu__decode_kernel)) / 4, 4, 0xbf810000
.section .rodata,"a"
.p2align 6
.amdhsa_kernel adaLN_cond__sliding_block_cached__glu_gated_reglu__decode_kernel
  .amdhsa_next_free_vgpr 152
  .amdhsa_next_free_sgpr 102
  .amdhsa_accum_offset 152
  .amdhsa_group_segment_fixed_size 0
  .amdhsa_kernarg_size 112
  .amdhsa_user_sgpr_count 2
  .amdhsa_user_sgpr_kernarg_segment_ptr 1
  .amdhsa_system_sgpr_workgroup_id_x 1
  .amdhsa_float_denorm_mode_32 3
.end_amdhsa_kernel
```
